```python
import torch

def _softmax(x, axis=-1):
    return torch.softmax(x, dim=axis)
def _gelu(x):
    return torch.nn.functional.gelu(x, approximate="tanh")
def _silu(x):
    return torch.nn.functional.silu(x)
def _sigmoid(x):
    return torch.sigmoid(x)
def _layernorm(x, axis=-1, eps=1e-5):
    m = x.mean(dim=axis, keepdim=True)
    v = x.var(dim=axis, keepdim=True, unbiased=False)
    return (x - m) / torch.sqrt(v + eps)
def _scatter_add(tgt, idx, src, axis=0):
    return tgt.clone().index_add_(axis, idx, src)
def _segment_sum(src, seg, n):
    out = torch.zeros((n,) + src.shape[1:], dtype=src.dtype)
    return out.index_add_(0, seg, src)
def _pad(x, pw):
    flat = tuple(v for pair in reversed(pw) for v in pair)
    return torch.nn.functional.pad(x, flat)

kernel_name = 'sequential_preLN__sliding_block_cached__dense_activation_mish__decode'

def setup_inputs():

    _w = (lambda a: (lambda t: t.to(torch.bfloat16) if t.is_floating_point() else t)(torch.as_tensor(a)))
    def _A_setup():
        B, Sq, D = 1, 1, 448
        Hq, Hkv, Sk, Dh = 16, 8, 8192, 256
        assert Hq % Hkv == 0, (Hq, Hkv)
        return {
            "x": _w((lambda *s: torch.randn(*s, dtype=torch.bfloat16) * 0.05)(B, Sq, D)),
            "k_cache": _w((lambda *s: torch.randn(*s, dtype=torch.bfloat16) * 1.6)(B, Hkv, Sk, Dh)),
            "v_cache": _w((lambda *s: torch.randn(*s, dtype=torch.bfloat16) * 0.4)(B, Hkv, Sk, Dh)),
            "wq": _w((lambda *s: torch.randn(*s, dtype=torch.bfloat16) * 1.6)(D, Hq * Dh) * (D ** -0.5)),
            "wo": _w((lambda *s: torch.randn(*s, dtype=torch.bfloat16) * 0.4)(Hq * Dh, D) * ((Hq * Dh) ** -0.5)),
        }
    _A_in = _A_setup()

    def _B_setup():
        B, S, D, F = 1, 1, 448, 1792
        return {
            "x": _w((lambda *s: torch.randn(*s, dtype=torch.bfloat16) * 0.05)(B, S, D)),
            "w1": _w((lambda *s: torch.randn(*s, dtype=torch.bfloat16) * 0.8)(D, F) * (D ** -0.5)),
            "b1": _w((lambda *s: torch.randn(*s, dtype=torch.bfloat16) * 0.2)(F)),
            "w2": _w((lambda *s: torch.randn(*s, dtype=torch.bfloat16) * 0.1)(F, D) * (F ** -0.5)),
        }
    _B_in = _B_setup()

    return {
        "A_x": _A_in["x"],
        "A_k_cache": _A_in["k_cache"],
        "A_v_cache": _A_in["v_cache"],
        "A_wq": _A_in["wq"],
        "A_wo": _A_in["wo"],
        "B_x": _B_in["x"],
        "B_w1": _B_in["w1"],
        "B_b1": _B_in["b1"],
        "B_w2": _B_in["w2"],
    }

def reference(A_x, A_k_cache, A_v_cache, A_wq, A_wo, B_x, B_w1, B_b1, B_w2):
    def _A_ref(x, k_cache, v_cache, wq, wo):
        B, Sq, D = x.shape
        Hq, Dh = 16, 256
        Hkv, Sk = k_cache.shape[1], k_cache.shape[2]
        W = min(4096, max(256, Sk // 4))
        rep = Hq // Hkv
        q = (lambda x, *d: x.permute(*d))((x @ wq).reshape(B, Sq, Hq, Dh), 0, 2, 1, 3)
        k = (lambda x, n, axis: torch.repeat_interleave(x, n, dim=axis))(k_cache[:, :, Sk - W:, :], rep, axis=1)
        v = (lambda x, n, axis: torch.repeat_interleave(x, n, dim=axis))(v_cache[:, :, Sk - W:, :], rep, axis=1)
        scores = torch.einsum("bhqd,bhkd->bhqk", q, k) * (Dh ** -0.5)
        p = _softmax(scores, axis=-1)
        o = torch.einsum("bhqk,bhkd->bhqd", p, v)
        return (lambda x, *d: x.permute(*d))(o, 0, 2, 1, 3).reshape(B, Sq, Hq * Dh) @ wo

    def _B_ref(x, w1, b1, w2):
        h = torch.einsum("bsd,df->bsf", x, w1) + b1
        sp = torch.log1p(torch.exp(-torch.abs(h))) + torch.where(h > 0, h, torch.zeros_like(h))
        act = h * torch.tanh(sp)
        return torch.einsum("bsf,fd->bsd", act, w2)

    x = A_x
    h = x + _A_ref(_layernorm(x, axis=-1), A_k_cache, A_v_cache, A_wq, A_wo)
    h2 = h + _B_ref(_layernorm(h, axis=-1), B_w1, B_b1, B_w2)
    return h2
```

```asm
; @launch grid=(256,1,1) block=(768,1,1) lds=81920
.amdgcn_target "amdgcn-amd-amdhsa--gfx950"
.text
.globl sequential_preLN__sliding_block_cached__dense_activation_mish__decode_kernel
.p2align 8
.type sequential_preLN__sliding_block_cached__dense_activation_mish__decode_kernel,@function
sequential_preLN__sliding_block_cached__dense_activation_mish__decode_kernel:
    s_cmp_ge_u32 s2, 256
    s_cbranch_scc1 L_end
    s_load_dwordx16 s[8:23], s[0:1], 0
    s_load_dwordx8 s[24:31], s[0:1], 64
    v_lshrrev_b32 v2, 6, v0
    v_and_b32 v1, 63, v0
    s_and_b32 s4, s2, 7
    s_lshr_b32 s5, s2, 3
    v_readfirstlane_b32 s3, v2
    v_lshrrev_b32 v3, 3, v1
    v_and_b32 v4, 7, v1
    v_mov_b32 v5, 0
    v_lshlrev_b32 v6, 2, v1
    ds_write_b32 v6, v5 offset:2048
    s_lshr_b32 s39, s5, 1
    s_and_b32 s33, s5, 1
    s_cmp_ge_u32 s3, 4
    s_cbranch_scc1 L_hi
    s_lshr_b32 s44, s5, 3
    s_and_b32 s45, s5, 7
    v_min_u32 v6, 55, v1
    v_lshlrev_b32 v6, 4, v6
    s_lshl_b32 s48, s3, 5
    v_lshl_add_u32 v15, v3, 2, s48
    v_min_u32 v14, 108, v15
    s_mul_i32 s47, s44, 112
    v_add_u32 v14, s47, v14
    v_lshlrev_b32 v12, 1, v14
    s_lshl_b32 s51, s4, 10
    s_lshl_b32 s52, s45, 7
    s_add_u32 s51, s51, s52
    v_lshl_add_u32 v32, v4, 4, s51
    v_lshl_add_u32 v32, v14, 13, v32
    v_add_u32 v33, 0x2000, v32
    v_add_u32 v34, 0x4000, v32
    v_add_u32 v35, 0x6000, v32
    s_waitcnt lgkmcnt(0)
    global_load_dwordx4 v[36:39], v6, s[8:9]
    global_load_dwordx2 v[12:13], v12, s[8:9]
    global_load_dwordx4 v[16:19], v32, s[14:15]
    global_load_dwordx4 v[20:23], v33, s[14:15]
    global_load_dwordx4 v[24:27], v34, s[14:15]
    global_load_dwordx4 v[28:31], v35, s[14:15]
    s_barrier
    s_branch L_s1
L_hi:
    s_lshl_b32 s43, s4, 22
    s_lshl_b32 s7, s39, 16
    s_add_u32 s43, s43, s7
    s_add_u32 s43, s43, 3145728
    s_and_b32 s44, s3, 3
    s_lshr_b32 s7, s3, 3
    s_cmp_eq_u32 s7, s33
    s_cbranch_scc0 L_B_hi
    s_lshl_b32 s47, s44, 11
    s_add_u32 s46, s43, s47
    v_lshlrev_b32 v6, 13, v3
    v_lshl_add_u32 v6, v4, 4, v6
    v_add_u32 v6, s46, v6
    s_mul_i32 s7, s33, 1536
    v_add_u32 v7, s7, v6
    s_waitcnt lgkmcnt(0)
    global_load_dwordx4 v[64:67], v7, s[10:11] offset:0
    global_load_dwordx4 v[68:71], v7, s[10:11] offset:128
    global_load_dwordx4 v[72:75], v7, s[10:11] offset:256
    global_load_dwordx4 v[76:79], v7, s[10:11] offset:384
    s_barrier
    s_cmp_eq_u32 s33, 1
    s_cbranch_scc1 L_A_k1
    global_load_dwordx4 v[80:83], v7, s[10:11] offset:512
    global_load_dwordx4 v[84:87], v7, s[10:11] offset:640
    global_load_dwordx4 v[88:91], v7, s[10:11] offset:768
    s_waitcnt vmcnt(6)
    global_load_dwordx4 v[92:95], v7, s[10:11] offset:896
    s_waitcnt vmcnt(6)
    global_load_dwordx4 v[96:99], v7, s[10:11] offset:1024
    s_waitcnt vmcnt(6)
    global_load_dwordx4 v[100:103], v7, s[10:11] offset:1152
    s_waitcnt vmcnt(6)
    global_load_dwordx4 v[104:107], v7, s[10:11] offset:1280
    s_waitcnt vmcnt(6)
    global_load_dwordx4 v[108:111], v7, s[10:11] offset:1408
    s_branch L_A_k1
L_B_hi:
    s_getpc_b64 s[36:37]
L_pc:
    v_and_b32 v5, 255, v0
    v_lshlrev_b32 v5, 7, v5
    v_cmp_gt_u32 vcc, L_codeend-L_pc, v5
    s_nop 1
    v_cndmask_b32 v5, 0, v5, vcc
    global_load_dword v167, v5, s[36:37]
    s_waitcnt lgkmcnt(0)
    s_barrier
    s_mul_i32 s7, s4, 458752
    s_load_dword s46, s[16:17], s7
    s_add_u32 s7, s7, 458748
    s_load_dword s47, s[16:17], s7
    s_load_dword s48, s[20:21], 0
    s_mov_b32 s7, 1605628
    s_load_dword s49, s[20:21], s7
    s_mul_i32 s7, s4, 200704
    s_load_dword s50, s[24:25], s7
    s_add_u32 s7, s7, 200700
    s_load_dword s51, s[24:25], s7
    s_load_dword s52, s[22:23], 0
    s_load_dword s53, s[26:27], 0
    s_load_dword s54, s[12:13], s43
    s_waitcnt lgkmcnt(0)
    s_cmp_eq_u32 s33, 1
    s_cbranch_scc0 L_A_v
    s_branch L_B_hi2
L_s1:
    s_mov_b32 s40, 0x05040100
    s_mov_b32 s41, 0x07060302
    s_mov_b32 s42, 0xffff0000
    v_lshlrev_b32 v2, 3, v4
    v_bfe_u32 v5, v1, 3, 1
    v_lshl_add_u32 v2, v5, 2, v2
    v_bfe_u32 v5, v1, 4, 1
    v_lshl_add_u32 v2, v5, 1, v2
    v_lshrrev_b32 v5, 5, v1
    v_add_u32 v2, v2, v5
    s_lshl_b32 s7, s3, 2
    v_mov_b32 v10, s7
    v_mov_b32 v11, 1
    v_cmp_gt_u32 vcc, 112, v15
    s_nop 0
    s_mov_b64 s[34:35], vcc
    s_cmp_lg_u32 s3, 3
    s_cbranch_scc1 L_s1_noep
    s_load_dword s6, s[30:31], 0
L_s1_noep:
    v_cmp_gt_u32 vcc, 56, v1
    s_waitcnt vmcnt(5)
    v_lshlrev_b32 v40, 16, v36
    v_and_b32 v41, s42, v36
    v_lshlrev_b32 v42, 16, v37
    v_and_b32 v43, s42, v37
    v_lshlrev_b32 v44, 16, v38
    v_and_b32 v45, s42, v38
    v_lshlrev_b32 v46, 16, v39
    v_and_b32 v47, s42, v39
    v_add_f32 v48, v40, v41
    v_mul_f32 v49, v40, v40
    v_add_f32 v50, v42, v43
    v_mul_f32 v51, v42, v42
    v_fmac_f32 v49, v41, v41
    v_fmac_f32 v51, v43, v43
    v_add_f32 v48, v48, v44
    v_add_f32 v50, v50, v46
    v_fmac_f32 v49, v44, v44
    v_fmac_f32 v51, v46, v46
    v_add_f32 v48, v48, v45
    v_add_f32 v50, v50, v47
    v_fmac_f32 v49, v45, v45
    v_fmac_f32 v51, v47, v47
    v_add_f32 v48, v48, v50
    v_add_f32 v49, v49, v51
    v_cndmask_b32 v48, 0, v48, vcc
    v_cndmask_b32 v49, 0, v49, vcc
    s_nop 0
    v_add_f32_dpp v48, v48, v48 quad_perm:[1,0,3,2] row_mask:0xf bank_mask:0xf
    v_add_f32_dpp v49, v49, v49 quad_perm:[1,0,3,2] row_mask:0xf bank_mask:0xf
    s_nop 0
    v_add_f32_dpp v48, v48, v48 quad_perm:[2,3,0,1] row_mask:0xf bank_mask:0xf
    v_add_f32_dpp v49, v49, v49 quad_perm:[2,3,0,1] row_mask:0xf bank_mask:0xf
    s_nop 0
    v_add_f32_dpp v48, v48, v48 row_half_mirror row_mask:0xf bank_mask:0xf
    v_add_f32_dpp v49, v49, v49 row_half_mirror row_mask:0xf bank_mask:0xf
    s_nop 0
    v_add_f32_dpp v48, v48, v48 row_mirror row_mask:0xf bank_mask:0xf
    v_add_f32_dpp v49, v49, v49 row_mirror row_mask:0xf bank_mask:0xf
    s_nop 0
    v_add_f32_dpp v48, v48, v48 row_bcast:15 row_mask:0xa bank_mask:0xf
    v_add_f32_dpp v49, v49, v49 row_bcast:15 row_mask:0xa bank_mask:0xf
    s_nop 0
    v_add_f32_dpp v48, v48, v48 row_bcast:31 row_mask:0xc bank_mask:0xf
    v_add_f32_dpp v49, v49, v49 row_bcast:31 row_mask:0xc bank_mask:0xf
    v_readlane_b32 s54, v48, 63
    v_readlane_b32 s55, v49, 63
    v_mov_b32 v52, 0x3b124925
    v_mul_f32 v50, s54, v52
    v_mul_f32 v51, s55, v52
    v_fma_f32 v51, -v50, v50, v51
    v_max_f32 v51, 0, v51
    v_cvt_pk_bf16_f32 v52, v50, v51
    v_lshlrev_b32 v50, 16, v52
    v_and_b32 v51, s42, v52
    v_add_f32 v51, 0x3727c5ac, v51
    v_cvt_pk_bf16_f32 v51, v51, v51
    v_and_b32 v51, s42, v51
    v_sqrt_f32 v51, v51
    s_nop 0
    v_cvt_pk_bf16_f32 v51, v51, v51
    v_and_b32 v51, s42, v51
    v_rcp_f32 v51, v51
    s_waitcnt vmcnt(4)
    v_lshlrev_b32 v40, 16, v12
    v_and_b32 v41, s42, v12
    v_lshlrev_b32 v42, 16, v13
    v_and_b32 v43, s42, v13
    v_sub_f32 v40, v40, v50
    v_sub_f32 v41, v41, v50
    v_sub_f32 v42, v42, v50
    v_sub_f32 v43, v43, v50
    v_cvt_pk_bf16_f32 v12, v40, v41
    v_cvt_pk_bf16_f32 v13, v42, v43
    v_lshlrev_b32 v40, 16, v12
    v_and_b32 v41, s42, v12
    v_lshlrev_b32 v42, 16, v13
    v_and_b32 v43, s42, v13
    v_mul_f32 v40, v40, v51
    v_mul_f32 v41, v41, v51
    v_mul_f32 v42, v42, v51
    v_mul_f32 v43, v43, v51
    v_cvt_pk_bf16_f32 v12, v40, v41
    v_cvt_pk_bf16_f32 v13, v42, v43
    v_cndmask_b32 v12, 0, v12, s[34:35]
    v_cndmask_b32 v13, 0, v13, s[34:35]
    v_lshlrev_b32 v5, 2, v0
    v_mov_b32 v6, 0
    s_waitcnt vmcnt(2)
    v_perm_b32 v40, v20, v16, s40
    v_perm_b32 v41, v20, v16, s41
    v_perm_b32 v42, v21, v17, s40
    v_perm_b32 v43, v21, v17, s41
    v_perm_b32 v44, v22, v18, s40
    v_perm_b32 v45, v22, v18, s41
    v_perm_b32 v46, v23, v19, s40
    v_perm_b32 v47, v23, v19, s41
    v_dot2_f32_bf16 v56, v40, v12, 0
    v_dot2_f32_bf16 v57, v41, v12, 0
    v_dot2_f32_bf16 v58, v42, v12, 0
    v_dot2_f32_bf16 v59, v43, v12, 0
    v_dot2_f32_bf16 v60, v44, v12, 0
    v_dot2_f32_bf16 v61, v45, v12, 0
    v_dot2_f32_bf16 v62, v46, v12, 0
    v_dot2_f32_bf16 v63, v47, v12, 0
    s_waitcnt vmcnt(0)
    v_perm_b32 v48, v28, v24, s40
    v_perm_b32 v49, v28, v24, s41
    v_perm_b32 v50, v29, v25, s40
    v_perm_b32 v51, v29, v25, s41
    v_perm_b32 v52, v30, v26, s40
    v_perm_b32 v53, v30, v26, s41
    v_perm_b32 v54, v31, v27, s40
    v_perm_b32 v55, v31, v27, s41
    v_dot2_f32_bf16 v56, v48, v13, v56
    v_dot2_f32_bf16 v57, v49, v13, v57
    v_dot2_f32_bf16 v58, v50, v13, v58
    v_dot2_f32_bf16 v59, v51, v13, v59
    v_dot2_f32_bf16 v60, v52, v13, v60
    v_dot2_f32_bf16 v61, v53, v13, v61
    v_dot2_f32_bf16 v62, v54, v13, v62
    v_dot2_f32_bf16 v63, v55, v13, v63
    v_permlane32_swap_b32 v56, v57
    v_permlane32_swap_b32 v58, v59
    v_permlane32_swap_b32 v60, v61
    v_permlane32_swap_b32 v62, v63
    v_add_f32 v56, v56, v57
    v_add_f32 v58, v58, v59
    v_add_f32 v60, v60, v61
    v_add_f32 v62, v62, v63
    v_permlane16_swap_b32 v56, v58
    s_nop 0
    v_permlane16_swap_b32 v60, v62
    v_add_f32 v56, v56, v58
    v_add_f32 v60, v60, v62
    s_nop 0
    v_add_f32_dpp v40, v56, v56 row_ror:8 row_mask:0xf bank_mask:0x3
    s_nop 1
    v_add_f32_dpp v40, v60, v60 row_ror:8 row_mask:0xf bank_mask:0xc
    s_cmp_eq_u32 s3, 3
    s_cbranch_scc1 L_s1_coll
    ds_write_b32 v5, v40 offset:0
    ds_write_b32 v10, v11 offset:2048
    s_load_dword s6, s[30:31], 0
    s_branch L_s1_done
L_s1_coll:
    v_lshlrev_b32 v5, 2, v1
    s_lshl_b32 s7, s4, 14
    s_lshl_b32 s51, s45, 11
    s_add_u32 s7, s7, s51
    s_lshl_b32 s51, s44, 9
    s_add_u32 s7, s7, s51
    s_add_u32 s7, s7, 65536
    v_lshl_add_u32 v8, v2, 3, s7
    s_mov_b32 s38, 100000
L_s1_1:
    ds_read_b128 v[56:59], v6 offset:2048
    ds_read_b32 v41, v5 offset:0
    ds_read_b32 v42, v5 offset:256
    ds_read_b32 v43, v5 offset:512
    s_waitcnt lgkmcnt(0)
    v_add3_u32 v56, v56, v57, v58
    v_add_u32 v56, v56, v59
    v_cmp_ne_u32 vcc, 3, v56
    s_nop 0
    s_cmp_eq_u64 vcc, 0
    s_cbranch_scc1 L_s1d_2
    s_sub_u32 s38, s38, 1
    s_cmp_eq_u32 s38, 0
    s_cbranch_scc0 L_s1_1
L_s1d_2:
    s_mul_i32 s7, s6, 0x9e3779b1
    s_add_u32 s7, s7, 0x7f4a7c15
    v_add_f32 v40, v40, v41
    v_add_f32 v42, v42, v43
    v_mov_b32 v41, s7
    v_add_f32 v40, v40, v42
    v_add_u32 v9, 1048576, v8
    global_store_dwordx2 v9, v[40:41], s[30:31]
    global_store_dwordx2 v8, v[40:41], s[30:31] sc1
    ds_write_b32 v6, v11 offset:2144
L_s1_done:
L_s1_done2:
    s_cmp_eq_u32 s33, 1
    s_cbranch_scc1 L_B_go
    s_setprio 3
    s_lshl_b32 s7, s4, 14
    s_lshl_b32 s51, s3, 12
    s_add_u32 s7, s7, s51
    s_add_u32 s7, s7, 65536
    v_lshl_add_u32 v9, v1, 4, s7
    s_lshl_b32 s7, s3, 8
    v_lshl_add_u32 v8, v1, 2, s7
    s_cmp_lg_u32 s3, 0
    s_cbranch_scc1 L_A_h2
    s_lshl_b32 s7, s4, 14
    s_lshl_b32 s51, s39, 9
    s_add_u32 s7, s7, s51
    s_add_u32 s7, s7, 524288
    v_lshrrev_b32 v5, 5, v1
    v_lshlrev_b32 v5, 13, v5
    v_and_b32 v7, 31, v1
    v_lshl_add_u32 v5, v7, 4, v5
    v_add_u32 v5, s7, v5
    v_mov_b32 v12, -1
    v_mov_b32 v13, -1
    v_mov_b32 v14, -1
    v_mov_b32 v15, -1
    global_store_dwordx4 v5, v[12:15], s[30:31] sc1
    s_lshl_b32 s7, s4, 14
    s_lshl_b32 s51, s39, 4
    s_add_u32 s7, s7, s51
    s_add_u32 s7, s7, 1572864
    v_lshl_add_u32 v5, v1, 8, s7
    global_store_dwordx4 v5, v[12:15], s[30:31]
    s_getreg_b32 s52, hwreg(HW_REG_XCC_ID)
    s_lshl_b32 s7, s4, 11
    s_lshl_b32 s51, s39, 7
    s_add_u32 s7, s7, s51
    s_add_u32 s7, s7, 360448
    v_mov_b32 v5, s7
    s_waitcnt vmcnt(0) lgkmcnt(0)
    s_mul_i32 s7, s6, 0x9e3779b1
    s_add_u32 s7, s7, 0x7f4a7c15
    v_mov_b32 v12, s7
    v_mov_b32 v13, s52
    s_mov_b64 exec, 1
    global_store_dwordx2 v5, v[12:13], s[30:31] sc1
    s_mov_b64 exec, -1
L_A_h2:
    s_mov_b32 s38, 100000
L_hg_3:
    ds_read_b128 v[56:59], v6 offset:2176
    s_waitcnt lgkmcnt(0)
    v_add3_u32 v56, v56, v57, v58
    v_add_u32 v56, v56, v59
    v_cmp_ne_u32 vcc, 4, v56
    s_nop 0
    s_cmp_eq_u64 vcc, 0
    s_cbranch_scc1 L_hgd_4
    s_sub_u32 s38, s38, 1
    s_cmp_eq_u32 s38, 0
    s_cbranch_scc0 L_hg_3
L_hgd_4:
    s_waitcnt lgkmcnt(0)
    s_mul_i32 s6, s6, 0x9e3779b1
    s_add_u32 s6, s6, 0x7f4a7c15
    v_mov_b32 v7, v9
    s_mov_b64 s[46:47], -1
    s_mov_b64 s[48:49], -1
    s_mov_b64 s[50:51], -1
    s_mov_b64 s[52:53], -1
    s_mov_b32 s38, 100000
L_qp_5:
    s_and_b32 s7, s38, 3
    s_cmp_eq_u32 s7, 1
    s_cselect_b32 s7, 0, 1048576
    v_add_u32 v9, s7, v7
    s_mov_b64 exec, s[46:47]
    s_cbranch_execz L_qps_7
    global_load_dwordx4 v[48:51], v9, s[30:31] offset:0 sc1
L_qps_7:
    s_mov_b64 exec, s[48:49]
    s_cbranch_execz L_qps_8
    global_load_dwordx4 v[52:55], v9, s[30:31] offset:1024 sc1
L_qps_8:
    s_mov_b64 exec, s[50:51]
    s_cbranch_execz L_qps_9
    global_load_dwordx4 v[56:59], v9, s[30:31] offset:2048 sc1
L_qps_9:
    s_mov_b64 exec, s[52:53]
    s_cbranch_execz L_qps_10
    global_load_dwordx4 v[60:63], v9, s[30:31] offset:3072 sc1
L_qps_10:
    s_mov_b64 exec, -1
    s_waitcnt vmcnt(0)
    v_xor_b32 v5, v49, v51
    v_cmp_ne_u32 s[46:47], s6, v49
    v_cmp_ne_u32 vcc, 0, v5
    s_nop 0
    s_or_b64 s[46:47], s[46:47], vcc
    v_xor_b32 v5, v53, v55
    v_cmp_ne_u32 s[48:49], s6, v53
    v_cmp_ne_u32 vcc, 0, v5
    s_nop 0
    s_or_b64 s[48:49], s[48:49], vcc
    v_xor_b32 v5, v57, v59
    v_cmp_ne_u32 s[50:51], s6, v57
    v_cmp_ne_u32 vcc, 0, v5
    s_nop 0
    s_or_b64 s[50:51], s[50:51], vcc
    v_xor_b32 v5, v61, v63
    v_cmp_ne_u32 s[52:53], s6, v61
    v_cmp_ne_u32 vcc, 0, v5
    s_nop 0
    s_or_b64 s[52:53], s[52:53], vcc
    s_or_b64 s[34:35], s[46:47], s[48:49]
    s_or_b64 s[34:35], s[34:35], s[50:51]
    s_or_b64 s[34:35], s[34:35], s[52:53]
    s_cmp_eq_u64 s[34:35], 0
    s_cbranch_scc1 L_qpd_6
    s_sub_u32 s38, s38, 1
    s_cmp_eq_u32 s38, 0
    s_cbranch_scc0 L_qp_5
L_qpd_6:
    v_add_f32 v48, v48, v52
    v_add_f32 v50, v50, v54
    v_add_f32 v56, v56, v60
    v_add_f32 v58, v58, v62
    s_nop 0
    v_permlane32_swap_b32 v48, v56
    v_permlane32_swap_b32 v50, v58
    v_add_f32 v48, v48, v56
    v_add_f32 v50, v50, v58
    v_cvt_pk_bf16_f32 v48, v48, v50
    ds_write_b32 v8, v48 offset:2304
    ds_write_b32 v10, v11 offset:2080
    s_cmp_eq_u32 s3, 0
    s_cbranch_scc1 L_A_soft
    s_endpgm
L_A_soft:
    v_lshlrev_b32 v5, 4, v1
    v_lshlrev_b32 v7, 3, v1
    s_lshl_b32 s7, s4, 11
    s_lshl_b32 s51, s39, 7
    s_add_u32 s7, s7, s51
    s_add_u32 s7, s7, 262144
    v_lshrrev_b32 v12, 5, v1
    s_lshl_b32 s51, s4, 8
    s_lshl_b32 s52, s39, 3
    s_add_u32 s51, s51, s52
    s_add_u32 s51, s51, 1310720
    v_lshl_add_u32 v13, v12, 7, s51
    v_lshl_add_u32 v12, v12, 3, s7
    v_mov_b32 v33, s6
    s_mov_b32 s34, 1
    s_mov_b32 s35, 1
    s_setprio 1
    s_mov_b32 s38, 100000
L_sc_11:
    ds_read_b128 v[56:59], v6 offset:2112
    ds_read_b128 v[16:19], v5 offset:3328
    s_waitcnt lgkmcnt(0)
    v_add3_u32 v56, v56, v57, v58
    v_add_u32 v56, v56, v59
    v_cmp_ne_u32 vcc, 4, v56
    s_nop 0
    s_cmp_eq_u64 vcc, 0
    s_cbranch_scc1 L_scd_12
    s_sub_u32 s38, s38, 1
    s_cmp_eq_u32 s38, 0
    s_cbranch_scc0 L_sc_11
L_scd_12:
    s_setprio 3
    v_max3_f32 v32, v16, v17, v18
    v_max_f32 v32, v32, v19
    s_nop 1
    v_max_f32_dpp v32, v32, v32 quad_perm:[1,0,3,2] row_mask:0xf bank_mask:0xf
    s_nop 1
    v_max_f32_dpp v32, v32, v32 quad_perm:[2,3,0,1] row_mask:0xf bank_mask:0xf
    s_nop 1
    v_max_f32_dpp v32, v32, v32 row_half_mirror row_mask:0xf bank_mask:0xf
    s_nop 1
    v_max_f32_dpp v32, v32, v32 row_mirror row_mask:0xf bank_mask:0xf
    v_mov_b32 v34, v32
    s_nop 1
    v_permlane16_swap_b32 v32, v34
    v_max_f32 v32, v32, v34
    v_sub_f32 v16, v16, v32
    v_sub_f32 v17, v17, v32
    v_sub_f32 v18, v18, v32
    v_sub_f32 v19, v19, v32
    v_exp_f32 v16, v16
    v_exp_f32 v17, v17
    v_exp_f32 v18, v18
    v_exp_f32 v19, v19
    v_add_f32 v35, v16, v17
    v_add_f32 v36, v18, v19
    v_add_f32 v35, v35, v36
    s_nop 1
    v_add_f32_dpp v35, v35, v35 quad_perm:[1,0,3,2] row_mask:0xf bank_mask:0xf
    s_nop 1
    v_add_f32_dpp v35, v35, v35 quad_perm:[2,3,0,1] row_mask:0xf bank_mask:0xf
    s_nop 1
    v_add_f32_dpp v35, v35, v35 row_half_mirror row_mask:0xf bank_mask:0xf
    s_nop 1
    v_add_f32_dpp v35, v35, v35 row_mirror row_mask:0xf bank_mask:0xf
    v_mov_b32 v34, v35
    s_nop 1
    v_permlane16_swap_b32 v35, v34
    v_add_f32 v35, v35, v34
    v_rcp_f32 v36, v35
    v_log_f32 v35, v35
    v_mul_f32 v16, v16, v36
    v_mul_f32 v17, v17, v36
    v_mul_f32 v18, v18, v36
    v_mul_f32 v19, v19, v36
    v_cvt_pk_bf16_f32 v16, v16, v17
    v_cvt_pk_bf16_f32 v17, v18, v19
    ds_write_b64 v7, v[16:17] offset:11520
    ds_write_b32 v6, v11 offset:2128
    v_add_f32 v32, v32, v35
    s_mov_b64 exec, s[34:35]
    global_store_dwordx2 v13, v[32:33], s[30:31]
    global_store_dwordx2 v12, v[32:33], s[30:31] sc1
    s_mov_b64 exec, -1
    s_setprio 0
    s_mul_i32 s7, s39, 28*3584
    s_mul_i32 s51, s4, 448
    s_add_u32 s7, s7, s51
    v_min_u32 v16, 6, v4
    v_min_u32 v17, 6, v3
    v_mul_u32_u24 v17, 3584, v17
    v_lshl_add_u32 v17, v16, 6, v17
    v_add_u32 v17, s7, v17
    s_mul_i32 s7, s4, 200704
    s_mul_i32 s51, s39, 12544
    s_add_u32 s7, s7, s51
    v_min_u32 v18, 48, v1
    v_lshl_add_u32 v18, v18, 6, s7
    s_mov_b32 s38, 100000
L_fp_13:
    ds_read_b128 v[56:59], v6 offset:2208
    s_waitcnt lgkmcnt(0)
    v_add3_u32 v56, v56, v57, v58
    v_add_u32 v56, v56, v59
    v_cmp_ne_u32 vcc, 4, v56
    s_nop 0
    s_cmp_eq_u64 vcc, 0
    s_cbranch_scc1 L_fpd_14
    s_sub_u32 s38, s38, 1
    s_cmp_eq_u32 s38, 0
    s_cbranch_scc0 L_fp_13
L_fpd_14:
    global_load_dword v40, v17, s[20:21]
    global_load_dword v44, v18, s[24:25]
    v_add_u32 v17, 25088, v17
    v_add_u32 v18, 3136, v18
    global_load_dword v41, v17, s[20:21]
    global_load_dword v45, v18, s[24:25]
    v_add_u32 v17, 25088, v17
    v_add_u32 v18, 3136, v18
    global_load_dword v42, v17, s[20:21]
    global_load_dword v46, v18, s[24:25]
    v_add_u32 v17, 25088, v17
    v_add_u32 v18, 3136, v18
    global_load_dword v43, v17, s[20:21]
    global_load_dword v47, v18, s[24:25]
    s_endpgm
L_A_k1:
    s_lshl_b32 s7, s44, 2
    v_mov_b32 v45, s7
    v_mov_b32 v46, 1
    v_mov_b32 v47, 0
    s_cmp_eq_u32 s33, 1
    s_cbranch_scc1 L_B_pf
    s_waitcnt vmcnt(3)
    ds_write_b32 v45, v46 offset:2176
    global_load_dwordx4 v[112:115], v6, s[10:11] offset:1536
    global_load_dwordx4 v[116:119], v6, s[10:11] offset:1664
    global_load_dwordx4 v[120:123], v6, s[10:11] offset:1792
    global_load_dwordx4 v[124:127], v6, s[10:11] offset:1920
    ds_write_b32 v45, v46 offset:2160
L_A_k2:
    s_mov_b32 s42, 0xffff0000
    s_lshl_b32 s7, s44, 4
    s_add_u32 s7, s7, 3328
    v_lshl_add_u32 v44, v3, 6, s7
    v_mov_b32 v47, 0
    v_lshlrev_b32 v5, 4, v4
    v_mov_b32 v48, 0
    v_mov_b32 v49, 0
    v_mov_b32 v50, 0
    v_mov_b32 v51, 0
    v_mov_b32 v52, 0
    v_mov_b32 v53, 0
    v_mov_b32 v54, 0
    v_mov_b32 v55, 0
    s_mov_b32 s7, 0x3db8aa3b
    s_mov_b32 s38, 100000
L_qx_15:
    ds_read_b128 v[56:59], v47 offset:2080
    s_waitcnt lgkmcnt(0)
    v_add3_u32 v56, v56, v57, v58
    v_add_u32 v56, v56, v59
    v_cmp_ne_u32 vcc, 4, v56
    s_nop 0
    s_cmp_eq_u64 vcc, 0
    s_cbranch_scc1 L_qxd_16
    s_sub_u32 s38, s38, 1
    s_cmp_eq_u32 s38, 0
    s_cbranch_scc0 L_qx_15
L_qxd_16:
    ds_read_b128 v[128:131], v5 offset:2304
    ds_read_b128 v[144:147], v5 offset:2816
    ds_read_b128 v[132:135], v5 offset:2432
    ds_read_b128 v[148:151], v5 offset:2944
    ds_read_b128 v[136:139], v5 offset:2560
    ds_read_b128 v[152:155], v5 offset:3072
    ds_read_b128 v[140:143], v5 offset:2688
    ds_read_b128 v[156:159], v5 offset:3200
    s_setprio 2
    s_waitcnt vmcnt(8)
    s_waitcnt lgkmcnt(6)
    v_dot2c_f32_bf16 v48, v64, v128
    v_dot2c_f32_bf16 v52, v64, v144
    v_dot2c_f32_bf16 v49, v80, v128
    v_dot2c_f32_bf16 v53, v80, v144
    v_dot2c_f32_bf16 v48, v65, v129
    v_dot2c_f32_bf16 v52, v65, v145
    v_dot2c_f32_bf16 v49, v81, v129
    v_dot2c_f32_bf16 v53, v81, v145
    v_dot2c_f32_bf16 v48, v66, v130
    v_dot2c_f32_bf16 v52, v66, v146
    v_dot2c_f32_bf16 v49, v82, v130
    v_dot2c_f32_bf16 v53, v82, v146
    v_dot2c_f32_bf16 v48, v67, v131
    v_dot2c_f32_bf16 v52, v67, v147
    v_dot2c_f32_bf16 v49, v83, v131
    v_dot2c_f32_bf16 v53, v83, v147
    s_waitcnt lgkmcnt(4)
    v_dot2c_f32_bf16 v48, v68, v132
    v_dot2c_f32_bf16 v52, v68, v148
    v_dot2c_f32_bf16 v49, v84, v132
    v_dot2c_f32_bf16 v53, v84, v148
    v_dot2c_f32_bf16 v48, v69, v133
    v_dot2c_f32_bf16 v52, v69, v149
    v_dot2c_f32_bf16 v49, v85, v133
    v_dot2c_f32_bf16 v53, v85, v149
    v_dot2c_f32_bf16 v48, v70, v134
    v_dot2c_f32_bf16 v52, v70, v150
    v_dot2c_f32_bf16 v49, v86, v134
    v_dot2c_f32_bf16 v53, v86, v150
    v_dot2c_f32_bf16 v48, v71, v135
    v_dot2c_f32_bf16 v52, v71, v151
    v_dot2c_f32_bf16 v49, v87, v135
    v_dot2c_f32_bf16 v53, v87, v151
    s_waitcnt lgkmcnt(2)
    v_dot2c_f32_bf16 v48, v72, v136
    v_dot2c_f32_bf16 v52, v72, v152
    v_dot2c_f32_bf16 v49, v88, v136
    v_dot2c_f32_bf16 v53, v88, v152
    v_dot2c_f32_bf16 v48, v73, v137
    v_dot2c_f32_bf16 v52, v73, v153
    v_dot2c_f32_bf16 v49, v89, v137
    v_dot2c_f32_bf16 v53, v89, v153
    v_dot2c_f32_bf16 v48, v74, v138
    v_dot2c_f32_bf16 v52, v74, v154
    v_dot2c_f32_bf16 v49, v90, v138
    v_dot2c_f32_bf16 v53, v90, v154
    v_dot2c_f32_bf16 v48, v75, v139
    v_dot2c_f32_bf16 v52, v75, v155
    v_dot2c_f32_bf16 v49, v91, v139
    v_dot2c_f32_bf16 v53, v91, v155
    s_waitcnt lgkmcnt(0)
    v_dot2c_f32_bf16 v48, v76, v140
    v_dot2c_f32_bf16 v52, v76, v156
    v_dot2c_f32_bf16 v49, v92, v140
    v_dot2c_f32_bf16 v53, v92, v156
    v_dot2c_f32_bf16 v48, v77, v141
    v_dot2c_f32_bf16 v52, v77, v157
    v_dot2c_f32_bf16 v49, v93, v141
    v_dot2c_f32_bf16 v53, v93, v157
    v_dot2c_f32_bf16 v48, v78, v142
    v_dot2c_f32_bf16 v52, v78, v158
    v_dot2c_f32_bf16 v49, v94, v142
    v_dot2c_f32_bf16 v53, v94, v158
    v_dot2c_f32_bf16 v48, v79, v143
    v_dot2c_f32_bf16 v52, v79, v159
    v_dot2c_f32_bf16 v49, v95, v143
    v_dot2c_f32_bf16 v53, v95, v159
    s_waitcnt vmcnt(0)
    v_dot2c_f32_bf16 v50, v96, v128
    v_dot2c_f32_bf16 v54, v96, v144
    v_dot2c_f32_bf16 v51, v112, v128
    v_dot2c_f32_bf16 v55, v112, v144
    v_dot2c_f32_bf16 v50, v97, v129
    v_dot2c_f32_bf16 v54, v97, v145
    v_dot2c_f32_bf16 v51, v113, v129
    v_dot2c_f32_bf16 v55, v113, v145
    v_dot2c_f32_bf16 v50, v98, v130
    v_dot2c_f32_bf16 v54, v98, v146
    v_dot2c_f32_bf16 v51, v114, v130
    v_dot2c_f32_bf16 v55, v114, v146
    v_dot2c_f32_bf16 v50, v99, v131
    v_dot2c_f32_bf16 v54, v99, v147
    v_dot2c_f32_bf16 v51, v115, v131
    v_dot2c_f32_bf16 v55, v115, v147
    v_dot2c_f32_bf16 v50, v100, v132
    v_dot2c_f32_bf16 v54, v100, v148
    v_dot2c_f32_bf16 v51, v116, v132
    v_dot2c_f32_bf16 v55, v116, v148
    v_dot2c_f32_bf16 v50, v101, v133
    v_dot2c_f32_bf16 v54, v101, v149
    v_dot2c_f32_bf16 v51, v117, v133
    v_dot2c_f32_bf16 v55, v117, v149
    v_dot2c_f32_bf16 v50, v102, v134
    v_dot2c_f32_bf16 v54, v102, v150
    v_dot2c_f32_bf16 v51, v118, v134
    v_dot2c_f32_bf16 v55, v118, v150
    v_dot2c_f32_bf16 v50, v103, v135
    v_dot2c_f32_bf16 v54, v103, v151
    v_dot2c_f32_bf16 v51, v119, v135
    v_dot2c_f32_bf16 v55, v119, v151
    v_dot2c_f32_bf16 v50, v104, v136
    v_dot2c_f32_bf16 v54, v104, v152
    v_dot2c_f32_bf16 v51, v120, v136
    v_dot2c_f32_bf16 v55, v120, v152
    v_dot2c_f32_bf16 v50, v105, v137
    v_dot2c_f32_bf16 v54, v105, v153
    v_dot2c_f32_bf16 v51, v121, v137
    v_dot2c_f32_bf16 v55, v121, v153
    v_dot2c_f32_bf16 v50, v106, v138
    v_dot2c_f32_bf16 v54, v106, v154
    v_dot2c_f32_bf16 v51, v122, v138
    v_dot2c_f32_bf16 v55, v122, v154
    v_dot2c_f32_bf16 v50, v107, v139
    v_dot2c_f32_bf16 v54, v107, v155
    v_dot2c_f32_bf16 v51, v123, v139
    v_dot2c_f32_bf16 v55, v123, v155
    v_dot2c_f32_bf16 v50, v108, v140
    v_dot2c_f32_bf16 v54, v108, v156
    v_dot2c_f32_bf16 v51, v124, v140
    v_dot2c_f32_bf16 v55, v124, v156
    v_dot2c_f32_bf16 v50, v109, v141
    v_dot2c_f32_bf16 v54, v109, v157
    v_dot2c_f32_bf16 v51, v125, v141
    v_dot2c_f32_bf16 v55, v125, v157
    v_dot2c_f32_bf16 v50, v110, v142
    v_dot2c_f32_bf16 v54, v110, v158
    v_dot2c_f32_bf16 v51, v126, v142
    v_dot2c_f32_bf16 v55, v126, v158
    v_dot2c_f32_bf16 v50, v111, v143
    v_dot2c_f32_bf16 v54, v111, v159
    v_dot2c_f32_bf16 v51, v127, v143
    v_dot2c_f32_bf16 v55, v127, v159
    v_add_f32_dpp v48, v48, v48 quad_perm:[1,0,3,2] row_mask:0xf bank_mask:0xf
    v_add_f32_dpp v49, v49, v49 quad_perm:[1,0,3,2] row_mask:0xf bank_mask:0xf
    v_add_f32_dpp v50, v50, v50 quad_perm:[1,0,3,2] row_mask:0xf bank_mask:0xf
    v_add_f32_dpp v51, v51, v51 quad_perm:[1,0,3,2] row_mask:0xf bank_mask:0xf
    v_add_f32_dpp v52, v52, v52 quad_perm:[1,0,3,2] row_mask:0xf bank_mask:0xf
    v_add_f32_dpp v53, v53, v53 quad_perm:[1,0,3,2] row_mask:0xf bank_mask:0xf
    v_add_f32_dpp v54, v54, v54 quad_perm:[1,0,3,2] row_mask:0xf bank_mask:0xf
    v_add_f32_dpp v55, v55, v55 quad_perm:[1,0,3,2] row_mask:0xf bank_mask:0xf
    v_add_f32_dpp v48, v48, v48 quad_perm:[2,3,0,1] row_mask:0xf bank_mask:0xf
    v_add_f32_dpp v49, v49, v49 quad_perm:[2,3,0,1] row_mask:0xf bank_mask:0xf
    v_add_f32_dpp v50, v50, v50 quad_perm:[2,3,0,1] row_mask:0xf bank_mask:0xf
    v_add_f32_dpp v51, v51, v51 quad_perm:[2,3,0,1] row_mask:0xf bank_mask:0xf
    v_add_f32_dpp v52, v52, v52 quad_perm:[2,3,0,1] row_mask:0xf bank_mask:0xf
    v_add_f32_dpp v53, v53, v53 quad_perm:[2,3,0,1] row_mask:0xf bank_mask:0xf
    v_add_f32_dpp v54, v54, v54 quad_perm:[2,3,0,1] row_mask:0xf bank_mask:0xf
    v_add_f32_dpp v55, v55, v55 quad_perm:[2,3,0,1] row_mask:0xf bank_mask:0xf
    v_add_f32_dpp v48, v48, v48 row_half_mirror row_mask:0xf bank_mask:0xf
    v_add_f32_dpp v49, v49, v49 row_half_mirror row_mask:0xf bank_mask:0xf
    v_add_f32_dpp v50, v50, v50 row_half_mirror row_mask:0xf bank_mask:0xf
    v_add_f32_dpp v51, v51, v51 row_half_mirror row_mask:0xf bank_mask:0xf
    v_add_f32_dpp v52, v52, v52 row_half_mirror row_mask:0xf bank_mask:0xf
    v_add_f32_dpp v53, v53, v53 row_half_mirror row_mask:0xf bank_mask:0xf
    v_add_f32_dpp v54, v54, v54 row_half_mirror row_mask:0xf bank_mask:0xf
    v_add_f32_dpp v55, v55, v55 row_half_mirror row_mask:0xf bank_mask:0xf
    v_cvt_pk_bf16_f32 v56, v48, v49
    v_cvt_pk_bf16_f32 v57, v50, v51
    v_cvt_pk_bf16_f32 v58, v52, v53
    v_cvt_pk_bf16_f32 v59, v54, v55
    v_lshlrev_b32 v48, 16, v56
    v_and_b32 v49, s42, v56
    v_lshlrev_b32 v50, 16, v57
    v_and_b32 v51, s42, v57
    v_lshlrev_b32 v52, 16, v58
    v_and_b32 v53, s42, v58
    v_lshlrev_b32 v54, 16, v59
    v_and_b32 v55, s42, v59
    v_mul_f32 v48, s7, v48
    v_mul_f32 v49, s7, v49
    v_mul_f32 v50, s7, v50
    v_mul_f32 v51, s7, v51
    v_mul_f32 v52, s7, v52
    v_mul_f32 v53, s7, v53
    v_mul_f32 v54, s7, v54
    v_mul_f32 v55, s7, v55
    ds_write_b128 v44, v[48:51]
    ds_write_b128 v44, v[52:55] offset:512
    ds_write_b32 v45, v46 offset:2112
    s_endpgm
L_A_v:
    s_mov_b32 s40, 0x05040100
    s_mov_b32 s41, 0x07060302
    s_lshl_b32 s52, s44, 7
    s_add_u32 s51, s43, s52
    v_bfe_u32 v5, v1, 3, 1
    v_lshlrev_b32 v6, 14, v5
    v_lshrrev_b32 v10, 4, v1
    v_lshl_add_u32 v6, v10, 12, v6
    v_lshl_add_u32 v6, v4, 4, v6
    v_add_u32 v6, s51, v6
    v_add_u32 v7, 0x8000, v6
    v_mov_b32 v11, 0
    s_lshl_b32 s7, s4, 14
    s_lshl_b32 s51, s39, 9
    s_add_u32 s7, s7, s51
    s_add_u32 s7, s7, s52
    s_add_u32 s7, s7, 524288
    v_lshlrev_b32 v8, 13, v5
    v_lshl_add_u32 v8, v4, 4, v8
    v_add_u32 v8, s7, v8
    s_lshl_b32 s7, s4, 14
    s_lshl_b32 s51, s44, 11
    s_add_u32 s7, s7, s51
    s_lshl_b32 s51, s39, 4
    s_add_u32 s7, s7, s51
    s_add_u32 s7, s7, 1572864
    v_lshlrev_b32 v12, 13, v5
    v_lshl_add_u32 v12, v4, 8, v12
    v_add_u32 v12, s7, v12
    s_lshl_b32 s7, s44, 2
    v_mov_b32 v13, s7
    v_mov_b32 v14, 1
    v_lshrrev_b32 v5, 1, v1
    v_xor_b32 v5, v5, v1
    v_and_b32 v5, 1, v5
    v_lshlrev_b32 v9, 8, v5
    v_and_b32 v5, 1, v1
    v_lshl_add_u32 v9, v5, 6, v9
    v_lshl_add_u32 v9, v10, 4, v9
    s_mov_b32 s38, 100000
L_vg_17:
    ds_read_b128 v[32:35], v11 offset:2080
    s_waitcnt lgkmcnt(0)
    v_add3_u32 v32, v32, v33, v34
    v_add_u32 v32, v32, v35
    v_cmp_ne_u32 vcc, 4, v32
    s_nop 0
    s_cmp_eq_u64 vcc, 0
    s_cbranch_scc1 L_vgd_18
    s_sub_u32 s38, s38, 1
    s_cmp_eq_u32 s38, 0
    s_cbranch_scc0 L_vg_17
L_vgd_18:
    global_load_dwordx4 v[40:43], v6, s[12:13] offset:0
    global_load_dwordx4 v[44:47], v6, s[12:13] offset:512
    global_load_dwordx4 v[48:51], v6, s[12:13] offset:1024
    global_load_dwordx4 v[52:55], v6, s[12:13] offset:1536
    global_load_dwordx4 v[56:59], v6, s[12:13] offset:2048
    global_load_dwordx4 v[60:63], v6, s[12:13] offset:2560
    global_load_dwordx4 v[64:67], v6, s[12:13] offset:3072
    global_load_dwordx4 v[68:71], v6, s[12:13] offset:3584
    global_load_dwordx4 v[72:75], v7, s[12:13] offset:0
    global_load_dwordx4 v[76:79], v7, s[12:13] offset:512
    global_load_dwordx4 v[80:83], v7, s[12:13] offset:1024
    global_load_dwordx4 v[84:87], v7, s[12:13] offset:1536
    global_load_dwordx4 v[88:91], v7, s[12:13] offset:2048
    global_load_dwordx4 v[92:95], v7, s[12:13] offset:2560
    global_load_dwordx4 v[96:99], v7, s[12:13] offset:3072
    global_load_dwordx4 v[100:103], v7, s[12:13] offset:3584
    s_waitcnt vmcnt(14)
    v_perm_b32 v104, v44, v40, s40
    v_perm_b32 v108, v44, v40, s41
    v_perm_b32 v112, v45, v41, s40
    v_perm_b32 v116, v45, v41, s41
    v_perm_b32 v120, v46, v42, s40
    v_perm_b32 v124, v46, v42, s41
    v_perm_b32 v128, v47, v43, s40
    v_perm_b32 v132, v47, v43, s41
    s_waitcnt vmcnt(12)
    v_perm_b32 v105, v52, v48, s40
    v_perm_b32 v109, v52, v48, s41
    v_perm_b32 v113, v53, v49, s40
    v_perm_b32 v117, v53, v49, s41
    v_perm_b32 v121, v54, v50, s40
    v_perm_b32 v125, v54, v50, s41
    v_perm_b32 v129, v55, v51, s40
    v_perm_b32 v133, v55, v51, s41
    s_waitcnt vmcnt(10)
    v_perm_b32 v106, v60, v56, s40
    v_perm_b32 v110, v60, v56, s41
    v_perm_b32 v114, v61, v57, s40
    v_perm_b32 v118, v61, v57, s41
    v_perm_b32 v122, v62, v58, s40
    v_perm_b32 v126, v62, v58, s41
    v_perm_b32 v130, v63, v59, s40
    v_perm_b32 v134, v63, v59, s41
    s_waitcnt vmcnt(8)
    v_perm_b32 v107, v68, v64, s40
    v_perm_b32 v111, v68, v64, s41
    v_perm_b32 v115, v69, v65, s40
    v_perm_b32 v119, v69, v65, s41
    v_perm_b32 v123, v70, v66, s40
    v_perm_b32 v127, v70, v66, s41
    v_perm_b32 v131, v71, v67, s40
    v_perm_b32 v135, v71, v67, s41
    s_waitcnt vmcnt(6)
    v_perm_b32 v40, v76, v72, s40
    v_perm_b32 v44, v76, v72, s41
    v_perm_b32 v48, v77, v73, s40
    v_perm_b32 v52, v77, v73, s41
    v_perm_b32 v56, v78, v74, s40
    v_perm_b32 v60, v78, v74, s41
    v_perm_b32 v64, v79, v75, s40
    v_perm_b32 v68, v79, v75, s41
    s_waitcnt vmcnt(4)
    v_perm_b32 v41, v84, v80, s40
    v_perm_b32 v45, v84, v80, s41
    v_perm_b32 v49, v85, v81, s40
    v_perm_b32 v53, v85, v81, s41
    v_perm_b32 v57, v86, v82, s40
    v_perm_b32 v61, v86, v82, s41
    v_perm_b32 v65, v87, v83, s40
    v_perm_b32 v69, v87, v83, s41
    s_mov_b32 s38, 100000
L_pw_19:
    ds_read_b128 v[32:35], v11 offset:2128
    ds_read_b128 v[16:19], v9 offset:11520
    ds_read_b128 v[20:23], v9 offset:11648
    s_waitcnt lgkmcnt(0)
    v_add3_u32 v32, v32, v33, v34
    v_add_u32 v32, v32, v35
    v_cmp_ne_u32 vcc, 1, v32
    s_nop 0
    s_cmp_eq_u64 vcc, 0
    s_cbranch_scc1 L_pwd_20
    s_sub_u32 s38, s38, 1
    s_cmp_eq_u32 s38, 0
    s_cbranch_scc0 L_pw_19
L_pwd_20:
    s_setprio 3
    v_mfma_f32_16x16x32_bf16 v[136:139], v[16:19], v[104:107], 0
    v_mfma_f32_16x16x32_bf16 v[140:143], v[16:19], v[108:111], 0
    v_mfma_f32_16x16x32_bf16 v[144:147], v[16:19], v[112:115], 0
    v_mfma_f32_16x16x32_bf16 v[148:151], v[16:19], v[116:119], 0
    v_mfma_f32_16x16x32_bf16 v[152:155], v[16:19], v[120:123], 0
    v_mfma_f32_16x16x32_bf16 v[156:159], v[16:19], v[124:127], 0
    v_mfma_f32_16x16x32_bf16 v[160:163], v[16:19], v[128:131], 0
    v_mfma_f32_16x16x32_bf16 v[164:167], v[16:19], v[132:135], 0
    s_waitcnt vmcnt(2)
    v_perm_b32 v42, v92, v88, s40
    v_perm_b32 v46, v92, v88, s41
    v_perm_b32 v50, v93, v89, s40
    v_perm_b32 v54, v93, v89, s41
    v_perm_b32 v58, v94, v90, s40
    v_perm_b32 v62, v94, v90, s41
    v_perm_b32 v66, v95, v91, s40
    v_perm_b32 v70, v95, v91, s41
    s_waitcnt vmcnt(0)
    v_perm_b32 v43, v100, v96, s40
    v_perm_b32 v47, v100, v96, s41
    v_perm_b32 v51, v101, v97, s40
    v_perm_b32 v55, v101, v97, s41
    v_perm_b32 v59, v102, v98, s40
    v_perm_b32 v63, v102, v98, s41
    v_perm_b32 v67, v103, v99, s40
    v_perm_b32 v71, v103, v99, s41
    v_mfma_f32_16x16x32_bf16 v[136:139], v[20:23], v[40:43], v[136:139]
    v_mfma_f32_16x16x32_bf16 v[140:143], v[20:23], v[44:47], v[140:143]
    v_mfma_f32_16x16x32_bf16 v[144:147], v[20:23], v[48:51], v[144:147]
    v_mfma_f32_16x16x32_bf16 v[148:151], v[20:23], v[52:55], v[148:151]
    v_mfma_f32_16x16x32_bf16 v[152:155], v[20:23], v[56:59], v[152:155]
    v_mfma_f32_16x16x32_bf16 v[156:159], v[20:23], v[60:63], v[156:159]
    v_mfma_f32_16x16x32_bf16 v[160:163], v[20:23], v[64:67], v[160:163]
    v_mfma_f32_16x16x32_bf16 v[164:167], v[20:23], v[68:71], v[164:167]
    s_nop 0
    v_add_f32_dpp v24, v139, v136 row_ror:8 row_mask:0xf bank_mask:0x3
    s_nop 1
    v_add_f32_dpp v24, v138, v137 row_ror:8 row_mask:0xf bank_mask:0xc
    v_add_f32_dpp v25, v143, v140 row_ror:8 row_mask:0xf bank_mask:0x3
    s_nop 1
    v_add_f32_dpp v25, v142, v141 row_ror:8 row_mask:0xf bank_mask:0xc
    v_add_f32_dpp v26, v147, v144 row_ror:8 row_mask:0xf bank_mask:0x3
    s_nop 1
    v_add_f32_dpp v26, v146, v145 row_ror:8 row_mask:0xf bank_mask:0xc
    v_add_f32_dpp v27, v151, v148 row_ror:8 row_mask:0xf bank_mask:0x3
    s_nop 1
    v_add_f32_dpp v27, v150, v149 row_ror:8 row_mask:0xf bank_mask:0xc
    v_add_f32_dpp v28, v155, v152 row_ror:8 row_mask:0xf bank_mask:0x3
    s_nop 1
    v_add_f32_dpp v28, v154, v153 row_ror:8 row_mask:0xf bank_mask:0xc
    v_add_f32_dpp v29, v159, v156 row_ror:8 row_mask:0xf bank_mask:0x3
    s_nop 1
    v_add_f32_dpp v29, v158, v157 row_ror:8 row_mask:0xf bank_mask:0xc
    v_add_f32_dpp v30, v163, v160 row_ror:8 row_mask:0xf bank_mask:0x3
    s_nop 1
    v_add_f32_dpp v30, v162, v161 row_ror:8 row_mask:0xf bank_mask:0xc
    v_add_f32_dpp v31, v167, v164 row_ror:8 row_mask:0xf bank_mask:0x3
    s_nop 1
    v_add_f32_dpp v31, v166, v165 row_ror:8 row_mask:0xf bank_mask:0xc
    v_cvt_pk_bf16_f32 v36, v24, v25
    v_cvt_pk_bf16_f32 v37, v26, v27
    v_cvt_pk_bf16_f32 v38, v28, v29
    v_cvt_pk_bf16_f32 v39, v30, v31
    v_min_u32 v36, -2, v36
    v_min_u32 v37, -2, v37
    v_min_u32 v38, -2, v38
    v_min_u32 v39, -2, v39
    s_mov_b64 exec, 0xffff
    global_store_dwordx4 v12, v[36:39], s[30:31]
    global_store_dwordx4 v8, v[36:39], s[30:31] sc1
    s_mov_b64 exec, -1
    ds_write_b32 v13, v14 offset:2208
    s_endpgm
L_B_pf:
    s_lshl_b32 s52, s44, 7
    s_add_u32 s51, s43, s52
    v_bfe_u32 v5, v1, 3, 1
    v_lshlrev_b32 v8, 14, v5
    v_lshrrev_b32 v10, 4, v1
    v_lshl_add_u32 v8, v10, 12, v8
    v_lshl_add_u32 v8, v4, 4, v8
    v_add_u32 v8, s51, v8
    v_add_u32 v9, 0x8000, v8
    s_waitcnt vmcnt(6)
    global_load_dwordx4 v[100:103], v8, s[12:13] offset:0
    s_waitcnt vmcnt(6)
    global_load_dwordx4 v[104:107], v8, s[12:13] offset:512
    s_waitcnt vmcnt(6)
    global_load_dwordx4 v[108:111], v8, s[12:13] offset:1024
    s_waitcnt vmcnt(6)
    global_load_dwordx4 v[112:115], v8, s[12:13] offset:1536
    s_waitcnt vmcnt(6)
    global_load_dwordx4 v[116:119], v8, s[12:13] offset:2048
    s_waitcnt vmcnt(6)
    global_load_dwordx4 v[120:123], v8, s[12:13] offset:2560
    s_mov_b32 s38, 100000
L_pg_21:
    ds_read_b128 v[56:59], v47 offset:2144
    s_waitcnt lgkmcnt(0)
    v_add3_u32 v56, v56, v57, v58
    v_add_u32 v56, v56, v59
    v_cmp_ne_u32 vcc, 1, v56
    s_nop 0
    s_cmp_eq_u64 vcc, 0
    s_cbranch_scc1 L_pgd_22
    s_sub_u32 s38, s38, 1
    s_cmp_eq_u32 s38, 0
    s_cbranch_scc0 L_pg_21
L_pgd_22:
    global_load_dwordx4 v[124:127], v8, s[12:13] offset:3072
    global_load_dwordx4 v[128:131], v8, s[12:13] offset:3584
    global_load_dwordx4 v[132:135], v9, s[12:13] offset:0
    global_load_dwordx4 v[136:139], v9, s[12:13] offset:512
    global_load_dwordx4 v[140:143], v9, s[12:13] offset:1024
    global_load_dwordx4 v[144:147], v9, s[12:13] offset:1536
    global_load_dwordx4 v[148:151], v9, s[12:13] offset:2048
    global_load_dwordx4 v[152:155], v9, s[12:13] offset:2560
    global_load_dwordx4 v[156:159], v9, s[12:13] offset:3072
    global_load_dwordx4 v[160:163], v9, s[12:13] offset:3584
    s_waitcnt vmcnt(12)
    ds_write_b32 v45, v46 offset:2160
    s_cmp_lt_u32 s39, 7
    s_cbranch_scc1 L_B_pf2
    s_sub_u32 s7, s39, 7
    s_lshl_b32 s7, s7, 2
    s_add_u32 s7, s7, s44
    s_mul_i32 s7, s7, 6400
    s_min_u32 s7, s7, 222976
    s_mul_i32 s51, s4, 458752
    s_add_u32 s7, s7, s51
    s_add_u32 s7, s7, 229376
    v_min_u32 v5, 49, v1
    v_lshl_add_u32 v5, v5, 7, s7
    global_load_dword v40, v5, s[16:17]
    s_sub_u32 s7, s39, 7
    s_lshl_b32 s7, s7, 2
    s_add_u32 s7, s7, s44
    s_mul_i32 s7, s7, 13
    v_mul_u32_u24 v5, 52, v1
    v_lshrrev_b32 v5, 8, v5
    v_mul_u32_u24 v6, 5, v5
    v_sub_u32 v6, v1, v6
    v_add_u32 v5, s7, v5
    v_min_u32 v5, 447, v5
    v_mul_u32_u24 v5, 3584, v5
    s_mul_i32 s7, s4, 448
    v_lshl_add_u32 v6, v6, 7, s7
    s_add_u32 s7, s7, 444
    v_min_u32 v6, s7, v6
    v_add_u32 v5, v5, v6
    global_load_dword v41, v5, s[20:21]
    s_waitcnt vmcnt(6)
    ds_write_b32 v45, v46 offset:2288
    s_waitcnt vmcnt(0)
    ds_write_b32 v45, v46 offset:2240
    s_branch L_B_pf3
L_B_pf2:
    s_cmp_eq_u32 s3, 8
    s_cbranch_scc0 L_B_pf3
    s_load_dword s6, s[30:31], 0
    s_lshl_b32 s7, s4, 11
    s_add_u32 s7, s7, 360448
    v_and_b32 v60, 15, v1
    v_lshl_add_u32 v61, v60, 7, s7
    s_getreg_b32 s54, hwreg(HW_REG_XCC_ID)
    s_setprio 3
    s_waitcnt lgkmcnt(0)
    s_mul_i32 s6, s6, 0x9e3779b1
    s_add_u32 s6, s6, 0x7f4a7c15
    s_mov_b64 s[46:47], -1
    s_mov_b32 s38, 100000
L_ra_23:
    s_mov_b64 exec, s[46:47]
    s_cbranch_execz L_ras_25
    global_load_dwordx2 v[62:63], v61, s[30:31] sc1
L_ras_25:
    s_mov_b64 exec, -1
    s_waitcnt vmcnt(0)
    v_cmp_ne_u32 s[46:47], s6, v62
    s_nop 0
    s_cmp_eq_u64 s[46:47], 0
    s_cbranch_scc1 L_rad_24
    s_sub_u32 s38, s38, 1
    s_cmp_eq_u32 s38, 0
    s_cbranch_scc0 L_ra_23
L_rad_24:
    v_cmp_ne_u32 vcc, s54, v63
    s_nop 0
    s_cmp_eq_u64 vcc, 0
    s_cselect_b32 s7, 2, 1
    v_mov_b32 v5, s7
    ds_write_b32 v47, v5 offset:2224
L_B_pf3:
    s_endpgm
L_B_hi2:
    s_cmp_lt_u32 s3, 7
    s_cbranch_scc1 L_B_join
L_w7:
    s_load_dword s6, s[30:31], 0
    v_mov_b32 v12, -1
    v_mov_b32 v13, -1
    v_mov_b32 v14, -1
    v_mov_b32 v15, -1
    s_cmp_lt_u32 s39, 14
    s_cbranch_scc0 L_B_exit
    s_cmp_lt_u32 s39, 7
    s_cbranch_scc0 L_w7_a
    s_lshl_b32 s7, s39, 3
    s_add_u32 s7, s7, s4
    s_lshl_b32 s7, s7, 7
    s_add_u32 s7, s7, 786432
    v_lshl_add_u32 v5, v4, 4, s7
    s_mov_b64 exec, 0xff
    global_store_dwordx4 v5, v[12:15], s[30:31] sc1
    s_mov_b64 exec, -1
    s_branch L_w7_b
L_w7_a:
    s_mul_i32 s57, s4, 7
    s_add_u32 s57, s57, s39
    s_sub_u32 s57, s57, 7
    s_mul_i32 s7, s57, 896
    s_add_u32 s7, s7, 851968
    v_min_u32 v6, 55, v1
    v_lshl_add_u32 v5, v6, 4, s7
    global_store_dwordx4 v5, v[12:15], s[30:31] sc1
    v_mov_b32 v6, 0
    global_load_ushort v16, v6, s[26:27]
L_w7_b:
    s_lshl_b32 s7, s39, 3
    s_add_u32 s7, s7, s4
    s_lshl_b32 s7, s7, 7
    s_add_u32 s7, s7, 327680
    v_mov_b32 v5, s7
    s_waitcnt vmcnt(0) lgkmcnt(0)
    s_mul_i32 s7, s6, 0x9e3779b1
    s_add_u32 s7, s7, 0x7f4a7c15
    v_mov_b32 v6, s7
    s_mov_b64 exec, 1
    global_store_dword v5, v6, s[30:31] sc1
    s_mov_b64 exec, -1
L_B_join:
    s_load_dword s6, s[30:31], 0
    s_mov_b32 s40, 0x05040100
    s_mov_b32 s41, 0x07060302
    s_mov_b32 s42, 0xffff0000
    v_lshlrev_b32 v2, 3, v4
    v_bfe_u32 v5, v1, 3, 1
    v_lshl_add_u32 v2, v5, 2, v2
    v_bfe_u32 v5, v1, 4, 1
    v_lshl_add_u32 v2, v5, 1, v2
    v_lshrrev_b32 v5, 5, v1
    v_add_u32 v2, v2, v5
L_B_go:
    s_cmp_lt_u32 s39, 14
    s_cbranch_scc0 L_B_exit
    v_mov_b32 v6, 0
    s_cmp_lt_u32 s39, 7
    s_cbranch_scc0 L_B_go_f
    s_mov_b32 s38, 100000
L_pubw_26:
    ds_read_b128 v[56:59], v6 offset:2144
    ds_read_b128 v[60:63], v6 offset:2160
    s_waitcnt lgkmcnt(0)
    v_add3_u32 v56, v56, v57, v58
    v_add3_u32 v60, v60, v61, v62
    v_add3_u32 v56, v56, v59, v63
    v_add_u32 v56, v56, v60
    v_cmp_ne_u32 vcc, 5, v56
    s_nop 0
    s_cmp_eq_u64 vcc, 0
    s_cbranch_scc1 L_pubwd_27
    s_sub_u32 s38, s38, 1
    s_cmp_eq_u32 s38, 0
    s_cbranch_scc0 L_pubw_26
L_pubwd_27:
    s_mul_i32 s6, s6, 0x9e3779b1
    s_add_u32 s6, s6, 0x7f4a7c15
    s_branch L_stage_wo
L_B_go_f:
    s_mov_b32 s38, 100000
L_pub_28:
    ds_read_b128 v[56:59], v6 offset:2144
    ds_read_b128 v[60:63], v6 offset:2160
    s_waitcnt lgkmcnt(0)
    v_add3_u32 v56, v56, v57, v58
    v_add3_u32 v60, v60, v61, v62
    v_add3_u32 v56, v56, v59, v63
    v_add_u32 v56, v56, v60
    v_cmp_ne_u32 vcc, 5, v56
    s_nop 0
    s_cmp_eq_u64 vcc, 0
    s_cbranch_scc1 L_pubd_29
    s_sub_u32 s38, s38, 1
    s_cmp_eq_u32 s38, 0
    s_cbranch_scc0 L_pub_28
L_pubd_29:
    s_mul_i32 s6, s6, 0x9e3779b1
    s_add_u32 s6, s6, 0x7f4a7c15
    s_branch L_stage_ffn
L_B_exit:
    s_endpgm
L_stage_wo:
    s_lshl_b32 s7, s4, 9
    s_lshl_b32 s51, s3, 6
    s_add_u32 s7, s7, s51
    s_mul_i32 s7, s7, 896
    s_lshl_b32 s51, s39, 7
    s_add_u32 s7, s7, s51
    v_mul_u32_u24 v5, 896, v3
    v_lshl_add_u32 v5, v4, 4, v5
    v_add_u32 v5, s7, v5
    global_load_dwordx4 v[8:11], v5, s[16:17]
    v_add_u32 v5, 7168, v5
    global_load_dwordx4 v[12:15], v5, s[16:17]
    v_add_u32 v5, 7168, v5
    global_load_dwordx4 v[16:19], v5, s[16:17]
    v_add_u32 v5, 7168, v5
    global_load_dwordx4 v[20:23], v5, s[16:17]
    v_add_u32 v5, 7168, v5
    global_load_dwordx4 v[24:27], v5, s[16:17]
    v_add_u32 v5, 7168, v5
    global_load_dwordx4 v[28:31], v5, s[16:17]
    v_add_u32 v5, 7168, v5
    global_load_dwordx4 v[32:35], v5, s[16:17]
    v_add_u32 v5, 7168, v5
    global_load_dwordx4 v[36:39], v5, s[16:17]
    v_and_b32 v60, 15, v1
    s_lshr_b32 s59, s3, 2
    s_and_b32 s58, s3, 3
    v_lshrrev_b32 v59, 4, v1
    s_lshl_b32 s7, s3, 13
    s_add_u32 s7, s7, 16384
    v_lshl_add_u32 v40, v1, 4, s7
    v_bfe_u32 v5, v1, 2, 2
    v_lshl_add_u32 v5, v59, 3, v5
    v_lshlrev_b32 v41, 7, v5
    v_and_b32 v5, 3, v1
    v_lshl_add_u32 v41, v5, 3, v41
    v_add_u32 v41, s7, v41
    v_bfe_u32 v5, v1, 4, 1
    v_lshlrev_b32 v45, 1, v5
    v_lshrrev_b32 v5, 5, v1
    v_add_u32 v45, v45, v5
    v_lshl_add_u32 v45, v45, 4, v60
    s_lshl_b32 s7, s3, 8
    v_lshl_add_u32 v45, v45, 2, s7
    v_and_b32 v5, 31, v1
    v_lshlrev_b32 v47, 3, v5
    s_lshl_b32 s7, s39, 3
    s_add_u32 s7, s7, s4
    s_lshl_b32 s7, s7, 7
    s_add_u32 s7, s7, 786432
    v_lshl_add_u32 v46, v5, 2, s7
    s_lshl_b32 s55, s4, 1
    s_add_u32 s55, s55, s59
    v_mov_b32 v6, 0
    s_mov_b32 s38, 100000
L_dec_30:
    ds_read_b32 v5, v6 offset:2224
    s_waitcnt lgkmcnt(0)
    v_readfirstlane_b32 s52, v5
    s_nop 0
    s_cmp_lg_u32 s52, 0
    s_cbranch_scc1 L_decd_31
    s_sub_u32 s38, s38, 1
    s_cmp_eq_u32 s38, 0
    s_cbranch_scc0 L_dec_30
L_decd_31:
    s_cmp_eq_u32 s52, 2
    s_cbranch_scc1 L_wo_fast
    s_lshl_b32 s7, s4, 11
    s_lshl_b32 s51, s59, 3
    s_add_u32 s7, s7, s51
    s_add_u32 s7, s7, 262144
    v_lshl_add_u32 v48, v59, 9, s7
    s_movk_i32 s61, 128
    s_lshl_b32 s7, s55, 13
    s_lshl_b32 s51, s58, 7
    s_add_u32 s7, s7, s51
    s_add_u32 s7, s7, 524288
    v_lshlrev_b32 v43, 9, v60
    v_lshl_add_u32 v43, v59, 4, v43
    v_add_u32 v43, s7, v43
    v_add_u32 v44, 64, v43
    s_branch L_wo_go
L_wo_fast:
    s_lshl_b32 s7, s55, 7
    s_add_u32 s7, s7, 1310720
    v_lshl_add_u32 v48, v59, 5, s7
    s_movk_i32 s61, 8
    s_lshl_b32 s7, s55, 13
    s_lshl_b32 s51, s58, 11
    s_add_u32 s7, s7, s51
    s_add_u32 s7, s7, 1572864
    v_lshl_add_u32 v43, v1, 4, s7
    v_add_u32 v44, 0x400, v43
L_wo_go:
    v_add_u32 v49, s61, v48
    v_add_u32 v50, s61, v49
    v_add_u32 v51, s61, v50
    s_waitcnt vmcnt(7)
    ds_write_b128 v40, v[8:11] offset:0
    s_waitcnt vmcnt(6)
    ds_write_b128 v40, v[12:15] offset:1024
    s_waitcnt vmcnt(5)
    ds_write_b128 v40, v[16:19] offset:2048
    s_waitcnt vmcnt(4)
    ds_write_b128 v40, v[20:23] offset:3072
    s_waitcnt vmcnt(3)
    ds_write_b128 v40, v[24:27] offset:4096
    s_waitcnt vmcnt(2)
    ds_write_b128 v40, v[28:31] offset:5120
    global_load_dwordx2 v[96:97], v48, s[30:31] sc1
    global_load_dwordx2 v[98:99], v49, s[30:31] sc1
    global_load_dwordx2 v[100:101], v50, s[30:31] sc1
    global_load_dwordx2 v[102:103], v51, s[30:31] sc1
    global_load_dwordx4 v[104:107], v43, s[30:31] sc1
    global_load_dwordx4 v[108:111], v44, s[30:31] sc1
    s_waitcnt vmcnt(7)
    ds_write_b128 v40, v[32:35] offset:6144
    s_waitcnt vmcnt(6)
    ds_write_b128 v40, v[36:39] offset:7168
    ds_read_b64_tr_b16 v[64:65], v41 offset:0
    ds_read_b64_tr_b16 v[66:67], v41 offset:512
    ds_read_b64_tr_b16 v[68:69], v41 offset:32
    ds_read_b64_tr_b16 v[70:71], v41 offset:544
    ds_read_b64_tr_b16 v[72:73], v41 offset:64
    ds_read_b64_tr_b16 v[74:75], v41 offset:576
    ds_read_b64_tr_b16 v[76:77], v41 offset:96
    ds_read_b64_tr_b16 v[78:79], v41 offset:608
    ds_read_b64_tr_b16 v[80:81], v41 offset:4096
    ds_read_b64_tr_b16 v[82:83], v41 offset:4608
    ds_read_b64_tr_b16 v[84:85], v41 offset:4128
    ds_read_b64_tr_b16 v[86:87], v41 offset:4640
    ds_read_b64_tr_b16 v[88:89], v41 offset:4160
    ds_read_b64_tr_b16 v[90:91], v41 offset:4672
    ds_read_b64_tr_b16 v[92:93], v41 offset:4192
    ds_read_b64_tr_b16 v[94:95], v41 offset:4704
    s_mov_b32 s38, 100000
    s_mov_b32 s60, 0
    s_branch L_opc_34
L_op_32:
    s_mov_b64 exec, s[46:47]
    s_cbranch_execz L_ops_36
    global_load_dwordx2 v[96:97], v48, s[30:31] sc1
L_ops_36:
    s_mov_b64 exec, s[48:49]
    s_cbranch_execz L_ops_37
    global_load_dwordx2 v[98:99], v49, s[30:31] sc1
L_ops_37:
    s_mov_b64 exec, s[50:51]
    s_cbranch_execz L_ops_38
    global_load_dwordx2 v[100:101], v50, s[30:31] sc1
L_ops_38:
    s_mov_b64 exec, s[52:53]
    s_cbranch_execz L_ops_39
    global_load_dwordx2 v[102:103], v51, s[30:31] sc1
L_ops_39:
    s_mov_b64 exec, s[54:55]
    s_cbranch_execz L_ops_40
    global_load_dwordx4 v[104:107], v43, s[30:31] sc1
L_ops_40:
    s_mov_b64 exec, s[56:57]
    s_cbranch_execz L_ops_41
    global_load_dwordx4 v[108:111], v44, s[30:31] sc1
L_ops_41:
    s_mov_b64 exec, -1
L_opc_34:
    s_waitcnt vmcnt(0)
    v_max3_u32 v52, v104, v105, v106
    v_max_u32 v52, v52, v107
    v_cmp_eq_u32 s[54:55], -1, v52
    v_max3_u32 v53, v108, v109, v110
    v_max_u32 v53, v53, v111
    v_cmp_eq_u32 s[56:57], -1, v53
    s_cmp_eq_u32 s60, 1
    s_cbranch_scc1 L_oph_35
    v_cmp_ne_u32 s[46:47], s6, v97
    v_cmp_ne_u32 s[48:49], s6, v99
    v_cmp_ne_u32 s[50:51], s6, v101
    v_cmp_ne_u32 s[52:53], s6, v103
    s_or_b64 s[34:35], s[46:47], s[48:49]
    s_or_b64 s[34:35], s[34:35], s[50:51]
    s_or_b64 s[34:35], s[34:35], s[52:53]
    s_cmp_eq_u64 s[34:35], 0
    s_cbranch_scc0 L_op_again
    v_max3_f32 v54, v96, v98, v100
    v_max_f32 v54, v54, v102
    v_mov_b32 v55, v54
    s_nop 1
    v_permlane16_swap_b32 v54, v55
    v_max_f32 v54, v54, v55
    v_mov_b32 v55, v54
    s_nop 1
    v_permlane32_swap_b32 v54, v55
    v_max_f32 v54, v54, v55
    v_sub_f32 v96, v96, v54
    v_sub_f32 v98, v98, v54
    v_sub_f32 v100, v100, v54
    v_sub_f32 v102, v102, v54
    v_exp_f32 v96, v96
    v_exp_f32 v98, v98
    v_exp_f32 v100, v100
    v_exp_f32 v102, v102
    v_add_f32 v54, v96, v98
    v_add_f32 v56, v100, v102
    v_add_f32 v54, v54, v56
    v_mov_b32 v55, v54
    s_nop 1
    v_permlane16_swap_b32 v54, v55
    v_add_f32 v54, v54, v55
    v_mov_b32 v55, v54
    s_nop 1
    v_permlane32_swap_b32 v54, v55
    v_add_f32 v54, v54, v55
    v_rcp_f32 v54, v54
    s_nop 0
    v_mul_f32 v96, v96, v54
    v_mul_f32 v98, v98, v54
    v_mul_f32 v100, v100, v54
    v_mul_f32 v102, v102, v54
    s_mov_b32 s60, 1
L_oph_35:
    s_or_b64 s[34:35], s[54:55], s[56:57]
    s_cmp_eq_u64 s[34:35], 0
    s_cbranch_scc1 L_opd_33
L_op_again:
    s_sub_u32 s38, s38, 1
    s_cmp_eq_u32 s38, 0
    s_cbranch_scc0 L_op_32
L_opd_33:
    s_waitcnt lgkmcnt(0)
    v_mfma_f32_16x16x32_bf16 v[112:115], v[104:107], v[64:67], 0
    v_mfma_f32_16x16x32_bf16 v[116:119], v[104:107], v[68:71], 0
    v_mfma_f32_16x16x32_bf16 v[120:123], v[104:107], v[72:75], 0
    v_mfma_f32_16x16x32_bf16 v[124:127], v[104:107], v[76:79], 0
    v_mfma_f32_16x16x32_bf16 v[112:115], v[108:111], v[80:83], v[112:115]
    v_mfma_f32_16x16x32_bf16 v[116:119], v[108:111], v[84:87], v[116:119]
    v_mfma_f32_16x16x32_bf16 v[120:123], v[108:111], v[88:91], v[120:123]
    v_mfma_f32_16x16x32_bf16 v[124:127], v[108:111], v[92:95], v[124:127]
    s_nop 4
    v_mul_f32 v52, v96, v112
    v_fmac_f32 v52, v98, v113
    v_fmac_f32 v52, v100, v114
    v_fmac_f32 v52, v102, v115
    v_mul_f32 v53, v96, v116
    v_fmac_f32 v53, v98, v117
    v_fmac_f32 v53, v100, v118
    v_fmac_f32 v53, v102, v119
    v_mul_f32 v54, v96, v120
    v_fmac_f32 v54, v98, v121
    v_fmac_f32 v54, v100, v122
    v_fmac_f32 v54, v102, v123
    v_mul_f32 v55, v96, v124
    v_fmac_f32 v55, v98, v125
    v_fmac_f32 v55, v100, v126
    v_fmac_f32 v55, v102, v127
    v_permlane32_swap_b32 v52, v53
    s_nop 0
    v_permlane32_swap_b32 v54, v55
    v_add_f32 v52, v52, v53
    v_add_f32 v54, v54, v55
    s_nop 1
    v_permlane16_swap_b32 v52, v54
    v_add_f32 v52, v52, v54
    ds_write_b32 v45, v52 offset:4352
    s_waitcnt lgkmcnt(0)
    s_barrier
    s_cmp_lg_u32 s3, 0
    s_cbranch_scc1 L_wo_end
    ds_read_b64 v[80:81], v47 offset:4352
    ds_read_b64 v[82:83], v47 offset:4608
    ds_read_b64 v[84:85], v47 offset:4864
    ds_read_b64 v[86:87], v47 offset:5120
    ds_read_b64 v[88:89], v47 offset:5376
    ds_read_b64 v[90:91], v47 offset:5632
    ds_read_b64 v[92:93], v47 offset:5888
    ds_read_b64 v[94:95], v47 offset:6144
    s_mov_b32 s34, -1
    s_mov_b32 s35, 0
    s_waitcnt lgkmcnt(0)
    v_add_f32 v80, v80, v82
    v_add_f32 v81, v81, v83
    v_add_f32 v84, v84, v86
    v_add_f32 v85, v85, v87
    v_add_f32 v88, v88, v90
    v_add_f32 v89, v89, v91
    v_add_f32 v92, v92, v94
    v_add_f32 v93, v93, v95
    v_add_f32 v80, v80, v84
    v_add_f32 v81, v81, v85
    v_add_f32 v88, v88, v92
    v_add_f32 v89, v89, v93
    v_add_f32 v80, v80, v88
    v_add_f32 v81, v81, v89
    v_cvt_pk_bf16_f32 v80, v80, v81
    v_min_u32 v80, -2, v80
    s_mov_b64 exec, s[34:35]
    global_store_dword v46, v80, s[30:31] sc1
    s_mov_b64 exec, -1
L_wo_end:
    s_endpgm
L_stage_ffn:
    s_mul_i32 s57, s4, 7
    s_add_u32 s57, s57, s39
    s_sub_u32 s57, s57, 7
    s_cmp_eq_u32 s3, 7
    s_cbranch_scc1 L_final
    s_lshl_b32 s7, s3, 10
    s_add_u32 s7, s7, 327680
    v_lshl_add_u32 v6, v4, 7, s7
    s_lshl_b32 s51, s3, 7
    v_lshl_add_u32 v5, v2, 1, s51
    global_load_ushort v40, v5, s[8:9]
    v_lshrrev_b32 v59, 4, v1
    v_and_b32 v60, 15, v1
    v_lshl_add_u32 v45, v59, 3, v4
    s_lshl_b32 s52, s57, 6
    v_lshl_add_u32 v5, v45, 1, s52
    global_load_ushort v42, v5, s[22:23]
    v_mov_b32 v122, v6
    global_load_dword v123, v122, s[30:31] sc1
    v_lshrrev_b32 v43, 2, v1
    v_and_b32 v44, 3, v1
    v_mov_b32 v61, 0
    s_mov_b32 s38, 100000
L_f2_42:
    ds_read_b128 v[112:115], v61 offset:2288
    s_waitcnt lgkmcnt(0)
    v_add3_u32 v112, v112, v113, v114
    v_add_u32 v112, v112, v115
    v_cmp_ne_u32 vcc, 4, v112
    s_nop 0
    s_cmp_eq_u64 vcc, 0
    s_cbranch_scc1 L_f2d_43
    s_sub_u32 s38, s38, 1
    s_cmp_eq_u32 s38, 0
    s_cbranch_scc0 L_f2_42
L_f2d_43:
    s_mul_i32 s7, s57, 28672
    s_lshl_b32 s51, s3, 7
    s_add_u32 s7, s7, s51
    v_mul_u32_u24 v6, 896, v3
    v_lshl_add_u32 v6, v4, 4, v6
    v_add_u32 v5, s7, v6
    global_load_dwordx4 v[24:27], v5, s[24:25]
    v_add_u32 v5, 7168, v5
    global_load_dwordx4 v[28:31], v5, s[24:25]
    v_add_u32 v5, 7168, v5
    global_load_dwordx4 v[32:35], v5, s[24:25]
    v_add_u32 v5, 7168, v5
    global_load_dwordx4 v[36:39], v5, s[24:25]
    s_mov_b32 s38, 100000
L_fg_44:
    ds_read_b128 v[112:115], v61 offset:2240
    s_waitcnt lgkmcnt(0)
    v_add3_u32 v112, v112, v113, v114
    v_add_u32 v112, v112, v115
    v_cmp_ne_u32 vcc, 4, v112
    s_nop 0
    s_cmp_eq_u64 vcc, 0
    s_cbranch_scc1 L_fgd_45
    s_sub_u32 s38, s38, 1
    s_cmp_eq_u32 s38, 0
    s_cbranch_scc0 L_fg_44
L_fgd_45:
    s_mul_i32 s7, s3, 229376
    s_lshl_b32 s52, s57, 6
    s_add_u32 s7, s7, s52
    v_mul_u32_u24 v5, 3584, v43
    v_lshl_add_u32 v5, v44, 4, v5
    v_add_u32 v5, s7, v5
    global_load_dwordx4 v[8:11], v5, s[20:21]
    v_add_u32 v5, 57344, v5
    global_load_dwordx4 v[12:15], v5, s[20:21]
    v_add_u32 v5, 57344, v5
    global_load_dwordx4 v[16:19], v5, s[20:21]
    v_add_u32 v5, 57344, v5
    global_load_dwordx4 v[20:23], v5, s[20:21]
    s_add_u32 s51, s51, 45056
    v_add_u32 v41, s51, v6
    s_lshl_b32 s7, s3, 12
    s_add_u32 s7, s7, 16384
    v_lshl_add_u32 v47, v1, 4, s7
    v_bfe_u32 v5, v1, 2, 2
    v_lshl_add_u32 v5, v59, 3, v5
    v_lshlrev_b32 v48, 6, v5
    v_lshl_add_u32 v48, v44, 3, v48
    v_add_u32 v48, s7, v48
    v_mul_u32_u24 v49, 896, v5
    v_lshl_add_u32 v49, v44, 3, v49
    s_lshl_b32 s7, s3, 8
    s_add_u32 s7, s7, 45056
    v_add_u32 v49, s7, v49
    s_lshl_b32 s7, s3, 10
    s_add_u32 s7, s7, 786432
    v_lshl_add_u32 v46, v1, 4, s7
    s_lshl_b32 s7, s3, 7
    v_lshl_add_u32 v50, v2, 1, s7
    v_lshl_add_u32 v51, v59, 4, s7
    s_lshl_b32 s7, s3, 2
    v_lshl_add_u32 v54, v60, 5, s7
    v_lshlrev_b32 v55, 5, v45
    s_mul_i32 s7, s57, 896
    s_lshl_b32 s51, s3, 8
    s_add_u32 s7, s7, s51
    s_add_u32 s7, s7, 851968
    v_lshl_add_u32 v62, v1, 1, s7
    s_mov_b32 s58, 0x55555555
    s_mov_b32 s59, 0x55555555
    s_lshl_b32 s7, s3, 3
    v_mov_b32 v63, s7
    v_mov_b32 v61, 0
    v_mov_b32 v96, 0x3f803f80
    v_mov_b32 v97, 0x3f803f80
    v_mov_b32 v98, 0x3f803f80
    v_mov_b32 v99, 0x3f803f80
    s_waitcnt vmcnt(7)
    ds_write_b128 v41, v[24:27] offset:0
    s_waitcnt vmcnt(6)
    ds_write_b128 v41, v[28:31] offset:7168
    s_waitcnt vmcnt(5)
    ds_write_b128 v41, v[32:35] offset:14336
    s_waitcnt vmcnt(4)
    ds_write_b128 v41, v[36:39] offset:21504
    s_waitcnt vmcnt(3)
    ds_write_b128 v47, v[8:11] offset:0
    s_waitcnt vmcnt(2)
    ds_write_b128 v47, v[12:15] offset:1024
    s_waitcnt vmcnt(1)
    ds_write_b128 v47, v[16:19] offset:2048
    s_waitcnt vmcnt(0)
    ds_write_b128 v47, v[20:23] offset:3072
    ds_read_b64_tr_b16 v[64:65], v48 offset:0
    ds_read_b64_tr_b16 v[66:67], v48 offset:256
    ds_read_b64_tr_b16 v[68:69], v48 offset:32
    ds_read_b64_tr_b16 v[70:71], v48 offset:288
    ds_read_b64_tr_b16 v[72:73], v48 offset:2048
    ds_read_b64_tr_b16 v[74:75], v48 offset:2304
    ds_read_b64_tr_b16 v[76:77], v48 offset:2080
    ds_read_b64_tr_b16 v[78:79], v48 offset:2336
    s_waitcnt lgkmcnt(0)
    v_mfma_f32_16x16x32_bf16 v[100:103], v[96:99], v[64:67], 0
    v_mfma_f32_16x16x32_bf16 v[104:107], v[96:99], v[68:71], 0
    v_mfma_f32_16x16x32_bf16 v[100:103], v[96:99], v[72:75], v[100:103]
    v_mfma_f32_16x16x32_bf16 v[104:107], v[96:99], v[76:79], v[104:107]
    s_nop 6
    ds_write_b32 v54, v100 offset:12032
    ds_write_b32 v54, v104 offset:12544
    s_waitcnt vmcnt(0) lgkmcnt(0)
    s_barrier
    ds_read_b128 v[100:103], v55 offset:12032
    ds_read_b128 v[104:107], v55 offset:12048
    s_cmp_gt_u32 s3, 3
    s_cbranch_scc1 L_ffn_now2
    ds_read_b64_tr_b16 v[128:129], v49 offset:0
    ds_read_b64_tr_b16 v[130:131], v49 offset:3584
    ds_read_b64_tr_b16 v[132:133], v49 offset:32
    ds_read_b64_tr_b16 v[134:135], v49 offset:3616
    ds_read_b64_tr_b16 v[136:137], v49 offset:64
    ds_read_b64_tr_b16 v[138:139], v49 offset:3648
    ds_read_b64_tr_b16 v[140:141], v49 offset:96
    ds_read_b64_tr_b16 v[142:143], v49 offset:3680
    s_cmp_eq_u32 s3, 3
    s_cbranch_scc1 L_ffn_now2
    ds_read_b64_tr_b16 v[144:145], v49 offset:128
    ds_read_b64_tr_b16 v[146:147], v49 offset:3712
    ds_read_b64_tr_b16 v[148:149], v49 offset:160
    ds_read_b64_tr_b16 v[150:151], v49 offset:3744
    ds_read_b64_tr_b16 v[152:153], v49 offset:192
    ds_read_b64_tr_b16 v[154:155], v49 offset:3776
    ds_read_b64_tr_b16 v[156:157], v49 offset:224
    ds_read_b64_tr_b16 v[158:159], v49 offset:3808
L_ffn_now2:
    v_lshlrev_b32 v40, 16, v40
    v_lshlrev_b32 v42, 16, v42
    s_mov_b32 s36, 0
    s_mov_b32 s37, 0x80000000
    v_mov_b32 v56, 0x3eaaaaab
    s_waitcnt lgkmcnt(0)
    v_add_f32 v100, v100, v101
    v_add_f32 v102, v102, v103
    v_add_f32 v104, v104, v105
    v_add_f32 v100, v100, v102
    v_add_f32 v104, v104, v106
    v_add_f32 v57, v100, v104
    v_cmp_ne_u32 vcc, s6, v123
    s_nop 0
    s_cmp_eq_u64 vcc, 0
    s_cbranch_scc1 L_tg_ok
    s_mov_b64 s[46:47], -1
    s_mov_b32 s38, 100000
L_tg_46:
    s_mov_b64 exec, s[46:47]
    s_cbranch_execz L_tgs_48
    global_load_dword v123, v122, s[30:31] sc1
L_tgs_48:
    s_mov_b64 exec, -1
    s_waitcnt vmcnt(0)
    v_cmp_ne_u32 s[46:47], s6, v123
    s_nop 0
    s_cmp_eq_u64 s[46:47], 0
    s_cbranch_scc1 L_tgd_47
    s_sub_u32 s38, s38, 1
    s_cmp_eq_u32 s38, 0
    s_cbranch_scc0 L_tg_46
L_tgd_47:
L_tg_ok:
    s_mov_b64 s[46:47], -1
    s_mov_b32 s38, 100000
L_yp_49:
    s_mov_b64 exec, s[46:47]
    s_cbranch_execz L_yps_51
    global_load_dwordx4 v[96:99], v46, s[30:31] sc1
L_yps_51:
    s_mov_b64 exec, -1
    s_waitcnt vmcnt(0)
    v_max3_u32 v52, v96, v97, v98
    v_max_u32 v52, v52, v99
    v_cmp_eq_u32 s[46:47], -1, v52
    s_nop 0
    s_cmp_eq_u64 s[46:47], 0
    s_cbranch_scc1 L_ypd_50
    s_sub_u32 s38, s38, 1
    s_cmp_eq_u32 s38, 0
    s_cbranch_scc0 L_yp_49
L_ypd_50:
    v_lshlrev_b32 v104, 16, v96
    v_and_b32 v105, s42, v96
    v_lshlrev_b32 v106, 16, v97
    v_and_b32 v107, s42, v97
    v_lshlrev_b32 v108, 16, v98
    v_and_b32 v109, s42, v98
    v_lshlrev_b32 v110, 16, v99
    v_and_b32 v111, s42, v99
    v_permlane32_swap_b32 v104, v105
    v_permlane32_swap_b32 v106, v107
    v_permlane32_swap_b32 v108, v109
    v_permlane32_swap_b32 v110, v111
    v_add_f32 v104, v104, v105
    v_add_f32 v106, v106, v107
    v_add_f32 v108, v108, v109
    v_add_f32 v110, v110, v111
    v_permlane16_swap_b32 v104, v106
    s_nop 0
    v_permlane16_swap_b32 v108, v110
    v_add_f32 v104, v104, v106
    v_add_f32 v108, v108, v110
    s_nop 0
    v_add_f32_dpp v52, v104, v104 row_ror:8 row_mask:0xf bank_mask:0x3
    s_nop 1
    v_add_f32_dpp v52, v108, v108 row_ror:8 row_mask:0xf bank_mask:0xc
    v_cvt_pk_bf16_f32 v52, v52, v52
    v_and_b32 v52, s42, v52
    v_add_f32 v52, v52, v40
    v_cvt_pk_bf16_f32 v52, v52, v52
    ds_write_b16 v50, v52 offset:6656
    ds_read_b128 v[96:99], v51 offset:6656
    ds_read_b128 v[112:115], v51 offset:6720
    v_and_b32 v52, s42, v52
    v_mul_f32 v53, v52, v52
    s_nop 0
    v_add_f32_dpp v52, v52, v52 quad_perm:[1,0,3,2] row_mask:0xf bank_mask:0xf
    v_add_f32_dpp v53, v53, v53 quad_perm:[1,0,3,2] row_mask:0xf bank_mask:0xf
    s_nop 0
    v_add_f32_dpp v52, v52, v52 quad_perm:[2,3,0,1] row_mask:0xf bank_mask:0xf
    v_add_f32_dpp v53, v53, v53 quad_perm:[2,3,0,1] row_mask:0xf bank_mask:0xf
    s_nop 0
    v_add_f32_dpp v52, v52, v52 row_half_mirror row_mask:0xf bank_mask:0xf
    v_add_f32_dpp v53, v53, v53 row_half_mirror row_mask:0xf bank_mask:0xf
    s_nop 0
    v_add_f32_dpp v52, v52, v52 row_mirror row_mask:0xf bank_mask:0xf
    v_add_f32_dpp v53, v53, v53 row_mirror row_mask:0xf bank_mask:0xf
    s_nop 0
    v_add_f32_dpp v52, v52, v52 row_bcast:15 row_mask:0xa bank_mask:0xf
    v_add_f32_dpp v53, v53, v53 row_bcast:15 row_mask:0xa bank_mask:0xf
    s_nop 0
    v_add_f32_dpp v52, v52, v52 row_bcast:31 row_mask:0xc bank_mask:0xf
    v_add_f32_dpp v53, v53, v53 row_bcast:31 row_mask:0xc bank_mask:0xf
    s_waitcnt lgkmcnt(0)
    v_mfma_f32_16x16x32_bf16 v[100:103], v[96:99], v[64:67], 0
    v_mfma_f32_16x16x32_bf16 v[104:107], v[96:99], v[68:71], 0
    v_mfma_f32_16x16x32_bf16 v[100:103], v[112:115], v[72:75], v[100:103]
    v_mfma_f32_16x16x32_bf16 v[104:107], v[112:115], v[76:79], v[104:107]
    s_mov_b64 exec, s[36:37]
    ds_write_b64 v63, v[52:53] offset:6400
    s_mov_b64 exec, -1
    s_nop 3
    ds_write_b32 v54, v100 offset:8448
    ds_write_b32 v54, v104 offset:8960
    s_waitcnt lgkmcnt(0)
    s_barrier
    s_cmp_gt_u32 s3, 3
    s_cbranch_scc1 L_wo_end
    ds_read_b128 v[108:111], v61 offset:6400
    ds_read_b128 v[112:115], v61 offset:6416
    ds_read_b128 v[116:119], v61 offset:6432
    ds_read_b64 v[120:121], v61 offset:6448
    ds_read_b128 v[100:103], v55 offset:8448
    ds_read_b128 v[104:107], v55 offset:8464
    s_mov_b32 s7, 0xbfb8aa3b
    s_waitcnt lgkmcnt(2)
    v_add_f32 v108, v108, v110
    v_add_f32 v109, v109, v111
    v_add_f32 v112, v112, v114
    v_add_f32 v113, v113, v115
    v_add_f32 v116, v116, v118
    v_add_f32 v117, v117, v119
    v_add_f32 v108, v108, v112
    v_add_f32 v109, v109, v113
    v_add_f32 v116, v116, v120
    v_add_f32 v117, v117, v121
    v_add_f32 v108, v108, v116
    v_add_f32 v109, v109, v117
    v_mov_b32 v58, 0x3b124925
    v_mul_f32 v52, v108, v58
    v_mul_f32 v53, v109, v58
    v_fma_f32 v53, -v52, v52, v53
    v_max_f32 v53, 0, v53
    v_cvt_pk_bf16_f32 v58, v52, v53
    v_lshlrev_b32 v52, 16, v58
    v_and_b32 v53, s42, v58
    v_add_f32 v53, 0x3727c5ac, v53
    v_cvt_pk_bf16_f32 v53, v53, v53
    v_and_b32 v53, s42, v53
    v_sqrt_f32 v53, v53
    s_nop 0
    v_cvt_pk_bf16_f32 v53, v53, v53
    v_and_b32 v53, s42, v53
    v_rcp_f32 v53, v53
    s_waitcnt lgkmcnt(0)
    v_add_f32 v100, v100, v101
    v_add_f32 v102, v102, v103
    v_add_f32 v104, v104, v105
    v_add_f32 v100, v100, v102
    v_add_f32 v104, v104, v106
    v_add_f32 v100, v100, v104
    v_fma_f32 v100, -v52, v57, v100
    v_mul_f32 v100, v100, v53
    v_cvt_pk_bf16_f32 v100, v100, v100
    v_and_b32 v100, s42, v100
    v_add_f32 v100, v100, v42
    v_cvt_pk_bf16_f32 v100, v100, v100
    v_and_b32 v100, s42, v100
    v_mul_f32 v101, s7, abs(v100)
    v_exp_f32 v101, v101
    v_max_f32 v107, 0, v100
    v_cvt_pk_bf16_f32 v101, v101, v101
    v_and_b32 v101, s42, v101
    v_add_f32 v102, 1.0, v101
    v_log_f32 v102, v102
    v_fma_f32 v103, v101, v56, -0.5
    v_fma_f32 v103, v101, v103, 1.0
    v_mul_f32 v103, v101, v103
    v_cmp_gt_f32 vcc, 0x3c800000, v101
    v_mul_f32 v102, 0x3f317218, v102
    s_nop 0
    v_cndmask_b32 v102, v102, v103, vcc
    v_cvt_pk_bf16_f32 v102, v102, v102
    v_and_b32 v102, s42, v102
    v_add_f32 v102, v102, v107
    v_cvt_pk_bf16_f32 v102, v102, v102
    v_and_b32 v102, s42, v102
    v_mul_f32 v103, 0xc038aa3b, v102
    v_exp_f32 v103, v103
    v_mul_f32 v105, v102, v102
    v_cmp_gt_f32 vcc, 0x3d000000, v102
    v_add_f32 v106, 1.0, v103
    v_sub_f32 v103, 1.0, v103
    v_rcp_f32 v106, v106
    v_mul_f32 v105, v105, v56
    v_fma_f32 v105, -v105, v102, v102
    v_mul_f32 v103, v103, v106
    v_cndmask_b32 v103, v103, v105, vcc
    v_cvt_pk_bf16_f32 v103, v103, v103
    v_and_b32 v103, s42, v103
    v_mul_f32 v100, v100, v103
    s_nop 1
    v_mov_b32_dpp v101, v100 quad_perm:[0,0,2,2] row_mask:0xf bank_mask:0xf
    v_mov_b32_dpp v102, v100 quad_perm:[1,1,3,3] row_mask:0xf bank_mask:0xf
    v_cvt_pk_bf16_f32 v101, v101, v102
    s_nop 1
    v_mov_b32_dpp v102, v101 row_half_mirror row_mask:0xf bank_mask:0xf
    v_mov_b32_dpp v96, v101 quad_perm:[0,0,0,0] row_mask:0xf bank_mask:0x5
    v_mov_b32_dpp v97, v101 quad_perm:[2,2,2,2] row_mask:0xf bank_mask:0x5
    v_mov_b32_dpp v98, v101 quad_perm:[0,0,0,0] row_mask:0xf bank_mask:0xa
    v_mov_b32_dpp v99, v101 quad_perm:[2,2,2,2] row_mask:0xf bank_mask:0xa
    s_nop 0
    v_mov_b32_dpp v98, v102 quad_perm:[2,2,2,2] row_mask:0xf bank_mask:0x5
    v_mov_b32_dpp v99, v102 quad_perm:[0,0,0,0] row_mask:0xf bank_mask:0x5
    v_mov_b32_dpp v96, v102 quad_perm:[2,2,2,2] row_mask:0xf bank_mask:0xa
    v_mov_b32_dpp v97, v102 quad_perm:[0,0,0,0] row_mask:0xf bank_mask:0xa
    s_nop 1
    v_mfma_f32_16x16x32_bf16 v[64:67], v[96:99], v[128:131], 0
    v_mfma_f32_16x16x32_bf16 v[68:71], v[96:99], v[132:135], 0
    v_mfma_f32_16x16x32_bf16 v[72:75], v[96:99], v[136:139], 0
    v_mfma_f32_16x16x32_bf16 v[76:79], v[96:99], v[140:143], 0
    s_cmp_eq_u32 s3, 3
    s_cbranch_scc1 L_ffn_last
    v_mfma_f32_16x16x32_bf16 v[80:83], v[96:99], v[144:147], 0
    v_mfma_f32_16x16x32_bf16 v[84:87], v[96:99], v[148:151], 0
    v_mfma_f32_16x16x32_bf16 v[88:91], v[96:99], v[152:155], 0
    v_mfma_f32_16x16x32_bf16 v[92:95], v[96:99], v[156:159], 0
    v_mov_b32_dpp v104, v64 quad_perm:[0,1,2,3] row_mask:0x1 bank_mask:0xf
    s_nop 1
    v_mov_b32_dpp v104, v68 quad_perm:[0,1,2,3] row_mask:0x2 bank_mask:0xf
    s_nop 1
    v_mov_b32_dpp v104, v72 quad_perm:[0,1,2,3] row_mask:0x4 bank_mask:0xf
    s_nop 1
    v_mov_b32_dpp v104, v76 quad_perm:[0,1,2,3] row_mask:0x8 bank_mask:0xf
    s_nop 1
    v_mov_b32_dpp v106, v104 quad_perm:[1,1,3,3] row_mask:0xf bank_mask:0xf
    v_cvt_pk_bf16_f32 v104, v104, v106
    v_min_u32 v104, -2, v104
    s_mov_b64 exec, s[58:59]
    global_store_dword v62, v104, s[30:31] offset:0 sc1
    s_mov_b64 exec, -1
    v_mov_b32_dpp v105, v80 quad_perm:[0,1,2,3] row_mask:0x1 bank_mask:0xf
    s_nop 1
    v_mov_b32_dpp v105, v84 quad_perm:[0,1,2,3] row_mask:0x2 bank_mask:0xf
    s_nop 1
    v_mov_b32_dpp v105, v88 quad_perm:[0,1,2,3] row_mask:0x4 bank_mask:0xf
    s_nop 1
    v_mov_b32_dpp v105, v92 quad_perm:[0,1,2,3] row_mask:0x8 bank_mask:0xf
    s_nop 1
    v_mov_b32_dpp v107, v105 quad_perm:[1,1,3,3] row_mask:0xf bank_mask:0xf
    v_cvt_pk_bf16_f32 v105, v105, v107
    v_min_u32 v105, -2, v105
    s_mov_b64 exec, s[58:59]
    global_store_dword v62, v105, s[30:31] offset:128 sc1
    s_mov_b64 exec, -1
    s_waitcnt vmcnt(0)
    v_mov_b32 v5, 1
    ds_write_b32 v63, v5 offset:2256
    s_endpgm
L_ffn_last:
    s_nop 7
    v_mov_b32_dpp v104, v64 quad_perm:[0,1,2,3] row_mask:0x1 bank_mask:0xf
    s_nop 1
    v_mov_b32_dpp v104, v68 quad_perm:[0,1,2,3] row_mask:0x2 bank_mask:0xf
    s_nop 1
    v_mov_b32_dpp v104, v72 quad_perm:[0,1,2,3] row_mask:0x4 bank_mask:0xf
    s_nop 1
    v_mov_b32_dpp v104, v76 quad_perm:[0,1,2,3] row_mask:0x8 bank_mask:0xf
    s_nop 1
    v_mov_b32_dpp v106, v104 quad_perm:[1,1,3,3] row_mask:0xf bank_mask:0xf
    v_cvt_pk_bf16_f32 v104, v104, v106
    v_min_u32 v104, -2, v104
    s_mov_b64 exec, s[58:59]
    global_store_dword v62, v104, s[30:31] offset:0 sc1
    s_mov_b64 exec, -1
    s_waitcnt vmcnt(0)
    v_mov_b32 v5, 1
    ds_write_b32 v63, v5 offset:2256
    s_endpgm
L_final:
    v_min_u32 v5, 55, v1
    v_mul_u32_u24 v5, 896, v5
    s_lshl_b32 s7, s57, 4
    s_add_u32 s7, s7, 851968
    v_add_u32 v5, s7, v5
    v_and_b32 v6, 7, v2
    s_lshl_b32 s7, s57, 3
    v_add_u32 v6, s7, v6
    v_lshlrev_b32 v6, 1, v6
    s_mov_b32 s36, 0x01010101
    s_mov_b32 s37, 0x01010101
    v_min_u32 v7, 55, v1
    v_lshlrev_b32 v7, 7, v7
    v_add_u32 v7, 334848, v7
    s_mov_b64 s[46:47], -1
    s_mov_b32 s38, 100000
L_rd_52:
    s_mov_b64 exec, s[46:47]
    s_cbranch_execz L_rds_54
    global_load_dword v8, v7, s[30:31] sc1
L_rds_54:
    s_mov_b64 exec, -1
    s_waitcnt vmcnt(0)
    v_cmp_ne_u32 s[46:47], s6, v8
    s_nop 0
    s_cmp_eq_u64 s[46:47], 0
    s_cbranch_scc1 L_rdd_53
    s_sub_u32 s38, s38, 1
    s_cmp_eq_u32 s38, 0
    s_cbranch_scc0 L_rd_52
L_rdd_53:
    s_barrier
    s_barrier
    ds_read_u16 v50, v6 offset:6656
    v_mov_b32 v10, 0
    v_mov_b32 v11, s6
    v_mov_b32 v9, 0
    s_mov_b32 s38, 100000
L_fd_55:
    ds_read_b128 v[56:59], v9 offset:2256
    ds_read_b128 v[60:63], v9 offset:2272
    s_waitcnt lgkmcnt(0)
    v_add3_u32 v56, v56, v57, v58
    v_add3_u32 v60, v60, v61, v62
    v_add3_u32 v56, v56, v59, v63
    v_add_u32 v56, v56, v60
    v_cmp_gt_u32 vcc, 4, v56
    s_nop 0
    s_cmp_eq_u64 vcc, 0
    s_cbranch_scc1 L_fdd_56
    s_sub_u32 s38, s38, 1
    s_cmp_eq_u32 s38, 0
    s_cbranch_scc0 L_fd_55
L_fdd_56:
    s_mov_b64 s[46:47], -1
    s_mov_b32 s38, 100000
L_fin_57:
    s_mov_b64 exec, s[46:47]
    s_cbranch_execz L_fins_59
    global_load_dwordx4 v[96:99], v5, s[30:31] sc1
L_fins_59:
    s_mov_b64 exec, -1
    s_waitcnt vmcnt(0)
    v_max3_u32 v48, v96, v97, v98
    v_max_u32 v48, v48, v99
    v_cmp_eq_u32 s[46:47], -1, v48
    s_nop 0
    s_cmp_eq_u64 s[46:47], 0
    s_cbranch_scc1 L_find_58
    s_sub_u32 s38, s38, 1
    s_cmp_eq_u32 s38, 0
    s_cbranch_scc0 L_fin_57
L_find_58:
    v_cmp_gt_u32 vcc, 56, v1
    s_waitcnt lgkmcnt(0)
    v_lshlrev_b32 v50, 16, v50
    v_cndmask_b32 v96, 0, v96, vcc
    v_cndmask_b32 v97, 0, v97, vcc
    v_cndmask_b32 v98, 0, v98, vcc
    v_cndmask_b32 v99, 0, v99, vcc
    v_lshlrev_b32 v100, 16, v96
    v_and_b32 v101, s42, v96
    v_lshlrev_b32 v102, 16, v97
    v_and_b32 v103, s42, v97
    v_lshlrev_b32 v104, 16, v98
    v_and_b32 v105, s42, v98
    v_lshlrev_b32 v106, 16, v99
    v_and_b32 v107, s42, v99
    v_permlane32_swap_b32 v100, v101
    v_permlane32_swap_b32 v102, v103
    v_permlane32_swap_b32 v104, v105
    v_permlane32_swap_b32 v106, v107
    v_add_f32 v100, v100, v101
    v_add_f32 v102, v102, v103
    v_add_f32 v104, v104, v105
    v_add_f32 v106, v106, v107
    v_permlane16_swap_b32 v100, v102
    s_nop 0
    v_permlane16_swap_b32 v104, v106
    v_add_f32 v100, v100, v102
    v_add_f32 v104, v104, v106
    s_nop 0
    v_add_f32_dpp v52, v100, v100 row_ror:8 row_mask:0xf bank_mask:0x3
    s_nop 1
    v_add_f32_dpp v52, v104, v104 row_ror:8 row_mask:0xf bank_mask:0xc
    s_nop 1
    v_add_f32_dpp v52, v52, v52 quad_perm:[1,0,3,2] row_mask:0xf bank_mask:0xf
    s_nop 1
    v_add_f32_dpp v52, v52, v52 quad_perm:[2,3,0,1] row_mask:0xf bank_mask:0xf
    s_nop 1
    v_add_f32_dpp v52, v52, v52 row_half_mirror row_mask:0xf bank_mask:0xf
    v_cvt_pk_bf16_f32 v52, v52, v52
    v_and_b32 v52, s42, v52
    v_add_f32 v52, v52, v50
    v_cvt_pk_bf16_f32 v52, v52, v52
    s_mov_b64 exec, s[36:37]
    global_store_short v6, v52, s[26:27]
    s_cmp_lg_u32 s57, 0
    s_cbranch_scc1 L_fin_end
    s_mov_b64 exec, 1
    global_store_dword v10, v11, s[30:31]
L_fin_end:
    s_mov_b64 exec, -1
    s_endpgm
L_end:
    s_endpgm
L_codeend:
.section .rodata,"a"
.p2align 6
.amdhsa_kernel sequential_preLN__sliding_block_cached__dense_activation_mish__decode_kernel
  .amdhsa_next_free_vgpr 168
  .amdhsa_next_free_sgpr 96
  .amdhsa_accum_offset 168
  .amdhsa_group_segment_fixed_size 0
  .amdhsa_kernarg_size 96
  .amdhsa_user_sgpr_count 2
  .amdhsa_user_sgpr_kernarg_segment_ptr 1
  .amdhsa_system_sgpr_workgroup_id_x 1
  .amdhsa_float_denorm_mode_32 3
.end_amdhsa_kernel
```
